```python
import torch

def _softmax(x, axis=-1):
    return torch.softmax(x, dim=axis)

def _gelu(x):
    return torch.nn.functional.gelu(x, approximate='tanh')

def _silu(x):
    return torch.nn.functional.silu(x)

def _sigmoid(x):
    return torch.sigmoid(x)

def _layernorm(x, axis=-1, eps=1e-05):
    m = x.mean(dim=axis, keepdim=True)
    v = x.var(dim=axis, keepdim=True, unbiased=False)
    return (x - m) / torch.sqrt(v + eps)

def _scatter_add(tgt, idx, src, axis=0):
    return tgt.clone().index_add_(axis, idx, src)

def _segment_sum(src, seg, n):
    out = torch.zeros((n,) + src.shape[1:], dtype=src.dtype)
    return out.index_add_(0, seg, src)

def _pad(x, pw):
    flat = tuple((v for pair in reversed(pw) for v in pair))
    return torch.nn.functional.pad(x, flat)
kernel_name = 'adaLN_cond__sliding_block_cached__geglu_ffn__decode'

def setup_inputs():

    _w = lambda a: (lambda t: t.to(torch.bfloat16) if t.is_floating_point() else t)(torch.as_tensor(a))

    def _A_setup():
        B, Sq, D = (1, 1, 1024)
        Hq, Hkv, Sk, Dh = (32, 4, 65536, 128)
        assert Hq % Hkv == 0, (Hq, Hkv)
        return {'x': _w((lambda *s: torch.randn(*s, dtype=torch.bfloat16) * 0.05)(B, Sq, D)), 'k_cache': _w((lambda *s: torch.randn(*s, dtype=torch.bfloat16) * 3.2)(B, Hkv, Sk, Dh)), 'v_cache': _w((lambda *s: torch.randn(*s, dtype=torch.bfloat16) * 0.4)(B, Hkv, Sk, Dh)), 'wq': _w((lambda *s: torch.randn(*s, dtype=torch.bfloat16) * 3.2)(D, Hq * Dh) * D ** (-0.5)), 'wo': _w((lambda *s: torch.randn(*s, dtype=torch.bfloat16) * 0.4)(Hq * Dh, D) * (Hq * Dh) ** (-0.5))}
    _A_in = _A_setup()

    def _B_setup():
        B, S, D, F = (1, 1, 1024, 3584)
        return {'x': _w((lambda *s: torch.randn(*s, dtype=torch.bfloat16) * 0.05)(B, S, D)), 'w_gate': _w((lambda *s: torch.randn(*s, dtype=torch.bfloat16) * 0.05)(D, F)), 'w_up': _w((lambda *s: torch.randn(*s, dtype=torch.bfloat16) * 0.05)(D, F)), 'w_down': _w((lambda *s: torch.randn(*s, dtype=torch.bfloat16) * 0.05)(F, D))}
    _B_in = _B_setup()
    return {'A_x': _A_in['x'], 'A_k_cache': _A_in['k_cache'], 'A_v_cache': _A_in['v_cache'], 'A_wq': _A_in['wq'], 'A_wo': _A_in['wo'], 'B_x': _B_in['x'], 'B_w_gate': _B_in['w_gate'], 'B_w_up': _B_in['w_up'], 'B_w_down': _B_in['w_down'], 'c': _w((lambda *s: torch.randn(*s, dtype=torch.bfloat16) * 0.2)(1, 1024) * 8.0), 'w_mod': _w((lambda *s: torch.randn(*s, dtype=torch.bfloat16) * 0.2)(1024, 6 * 1024) * 1024 ** (-0.5) * 8.0)}

def reference(A_x, A_k_cache, A_v_cache, A_wq, A_wo, B_x, B_w_gate, B_w_up, B_w_down, c, w_mod):

    def _A_ref(x, k_cache, v_cache, wq, wo):
        B, Sq, D = x.shape
        Hq, Dh = (32, 128)
        Hkv, Sk = (k_cache.shape[1], k_cache.shape[2])
        W = min(4096, max(256, Sk // 4))
        rep = Hq // Hkv
        q = (lambda x, *d: x.permute(*d))((x @ wq).reshape(B, Sq, Hq, Dh), 0, 2, 1, 3)
        k = (lambda x, n, axis: torch.repeat_interleave(x, n, dim=axis))(k_cache[:, :, Sk - W:, :], rep, axis=1)
        v = (lambda x, n, axis: torch.repeat_interleave(x, n, dim=axis))(v_cache[:, :, Sk - W:, :], rep, axis=1)
        scores = torch.einsum('bhqd,bhkd->bhqk', q, k) * Dh ** (-0.5)
        p = _softmax(scores, axis=-1)
        o = torch.einsum('bhqk,bhkd->bhqd', p, v)
        return (lambda x, *d: x.permute(*d))(o, 0, 2, 1, 3).reshape(B, Sq, Hq * Dh) @ wo

    def _B_ref(x, w_gate, w_up, w_down):
        return _gelu(x @ w_gate) * (x @ w_up) @ w_down
    x = A_x
    mod = (_silu(c) @ w_mod).reshape(c.shape[0], 6, 1, -1)
    sa, ca, ga, sb, cb, gb = (mod[:, 0].clone(), mod[:, 1].clone(), mod[:, 2].clone(), mod[:, 3].clone(), mod[:, 4].clone(), mod[:, 5].clone())
    h = _layernorm(x, axis=-1) * (1 + ca) + sa
    x = x + ga * _A_ref(h, A_k_cache, A_v_cache, A_wq, A_wo)
    h = _layernorm(x, axis=-1) * (1 + cb) + sb
    x = x + gb * _B_ref(h, B_w_gate, B_w_up, B_w_down)
    return x
```

```asm
; @launch grid=(256,1,1) block=(576,1,1) lds=160128
.amdgcn_target "amdgcn-amd-amdhsa--gfx950"
.text
.globl adaLN_cond__sliding_block_cached__geglu_ffn__decode_kernel
.p2align 8
.type adaLN_cond__sliding_block_cached__geglu_ffn__decode_kernel,@function
adaLN_cond__sliding_block_cached__geglu_ffn__decode_kernel:
  s_cmp_ge_u32 s2, 256
  s_cbranch_scc1 EXIT
  s_load_dwordx16 s[8:23], s[0:1], 0
  s_load_dwordx8 s[24:31], s[0:1], 64
  s_load_dwordx4 s[32:35], s[0:1], 96
  v_lshrrev_b32 v2, 6, v0
  v_and_b32 v1, 63, v0
  s_and_b32 s3, s2, 7
  s_lshl_b32 s3, s3, 5
  s_lshr_b32 s6, s2, 3
  s_add_u32 s3, s3, s6
  v_readfirstlane_b32 s4, v2
  v_lshrrev_b32 v2, 3, v1
  v_and_b32 v9, 7, v1
  v_lshlrev_b32 v9, 4, v9
  s_mov_b32 s49, 0x200000
  s_and_b32 s54, s3, 63
  s_lshr_b32 s55, s3, 6
  s_and_b32 s56, s3, 15
  s_lshr_b32 s57, s3, 4
  s_cmp_ge_u32 s3, 112
  s_cselect_b32 s58, 1, 0
  s_mul_i32 s6, s58, 112
  s_sub_u32 s60, s3, s6
  s_cmp_ge_u32 s60, 56
  s_cselect_b32 s59, 1, 0
  s_mul_i32 s6, s59, 56
  s_sub_u32 s60, s60, s6
  v_mov_b32 v15, 147456
  v_mov_b32 v162, 1
  v_mov_b32 v126, 0
  v_mov_b32 v14, 0
  v_lshl_add_u32 v12, v1, 2, v15
  s_mov_b32 exec_hi, 0
  ds_write_b32 v12, v14
  s_mov_b64 exec, -1
  s_waitcnt lgkmcnt(0)
  s_cmp_eq_u32 s4, 8
  s_cbranch_scc1 LOADER
  s_lshl_b32 s61, s4, 5
  s_lshr_b32 s6, s3, 5
  s_lshl_b32 s6, s6, 7
  s_add_u32 s62, s6, s61
  s_lshl_b32 s6, s55, 8
  s_add_u32 s63, s6, s61
  v_mul_u32_u24 v12, 49152, v2
  v_add_u32 v12, v12, v9
  s_mul_i32 s64, s62, 12288
  s_and_b32 s6, s3, 31
  s_lshl_b32 s6, s6, 7
  s_add_u32 s64, s64, s6
  v_lshlrev_b32 v13, 3, v2
  v_lshlrev_b32 v14, 5, v1
  s_lshl_b32 s65, s62, 1
  s_lshl_b32 s66, s63, 1
  s_load_dword s5, s[34:35], 0
  s_mov_b32 s40, s28
  s_mov_b32 s41, s29
  s_mov_b32 s42, 12582912
  s_mov_b32 s43, 0x20000
  s_cmp_ge_u32 s4, 4
  s_cbranch_scc1 CLEAR
  buffer_load_dwordx4 v[64:67], v12, s[40:43], s64 offen nt
  s_add_u32 s64, s64, 12288
  buffer_load_dwordx4 v[68:71], v12, s[40:43], s64 offen nt
  s_add_u32 s64, s64, 12288
  buffer_load_dwordx4 v[72:75], v12, s[40:43], s64 offen nt
  s_add_u32 s64, s64, 12288
  buffer_load_dwordx4 v[76:79], v12, s[40:43], s64 offen nt
  s_add_u32 s64, s64, 12288
NOP1LD:
  s_mov_b32 s40, s26
  s_mov_b32 s41, s27
  s_mov_b32 s42, 2048
  s_mov_b32 s43, 0x20000
  buffer_load_dwordx2 v[20:21], v13, s[40:43], s65 offen
  buffer_load_dwordx2 v[22:23], v13, s[40:43], s66 offen
  s_mov_b32 s40, s8
  s_mov_b32 s41, s9
  s_mov_b32 s42, 2048
  s_mov_b32 s43, 0x20000
  buffer_load_dwordx2 v[24:25], v13, s[40:43], s66 offen
  buffer_load_dwordx4 v[136:139], v14, s[40:43], 0 offen
  buffer_load_dwordx4 v[140:143], v14, s[40:43], 0 offen offset:16
  v_and_b32 v12, 15, v1
  v_lshlrev_b32 v12, 4, v12
  v_bfe_u32 v14, v1, 4, 1
  v_lshl_add_u32 v12, v14, 3, v12
  s_lshl_b32 s6, s4, 8
  buffer_load_dwordx2 v[156:157], v12, s[40:43], s6 offen
  s_mov_b32 s36, s34
  s_mov_b32 s37, s35
  s_mov_b32 s38, 1601536
  s_mov_b32 s39, 0x20000
  s_barrier
  s_mov_b32 s48, 0xffff0000
  s_mov_b32 s82, 0x55555555
  s_mov_b32 s83, s82
  v_and_b32 v12, 1, v1
  v_cmp_eq_u32 vcc, 1, v12
  v_mov_b32 v13, 0xffff
  v_mov_b32 v14, s48
  v_cndmask_b32 v13, v13, v14, vcc
  v_bfe_u32 v12, v1, 1, 2
  v_cmp_eq_u32 vcc, 0, v12
  s_nop 1
  v_cndmask_b32 v3, 0, v13, vcc
  v_cmp_eq_u32 vcc, 1, v12
  s_nop 1
  v_cndmask_b32 v4, 0, v13, vcc
  v_cmp_eq_u32 vcc, 2, v12
  s_nop 1
  v_cndmask_b32 v5, 0, v13, vcc
  v_cmp_eq_u32 vcc, 3, v12
  s_nop 1
  v_cndmask_b32 v6, 0, v13, vcc
  v_lshrrev_b32 v12, 5, v1
  v_lshlrev_b32 v8, 8, v12
  v_lshl_add_u32 v8, v9, 1, v8
  v_and_b32 v12, 16, v1
  v_add_u32 v8, v8, v12
  s_lshl_b32 s6, s4, 9
  s_add_u32 s6, s6, 147584
  v_add_u32 v8, s6, v8
  v_and_b32 v163, 15, v1
  v_lshlrev_b32 v163, 4, v163
  v_lshrrev_b32 v164, 4, v1
  v_lshl_add_u32 v10, v164, 10, v163
  v_add_u32 v10, 147584, v10
  s_lshl_b32 s6, s4, 12
  v_lshlrev_b32 v11, 4, v1
  v_add_u32 v11, s6, v11
  s_mov_b32 s52, 0x00ff00ff
  s_mov_b32 s53, 0xff00ff00
  s_waitcnt lgkmcnt(0)
  s_add_u32 s5, s5, 1
  v_and_b32 v158, 0x3f803f80, v3
  v_and_b32 v159, 0x3f803f80, v4
  v_and_b32 v160, 0x3f803f80, v5
  v_and_b32 v161, 0x3f803f80, v6
  s_cmp_ge_u32 s4, 4
  s_cbranch_scc1 CLRW
  s_waitcnt vmcnt(5)
  v_and_b32 v59, s48, v21
  v_lshlrev_b32 v58, 16, v21
  v_and_b32 v57, s48, v20
  v_lshlrev_b32 v56, 16, v20
  v_mul_f32 v60, 0xbfb8aa3b, v56
  v_mul_f32 v61, 0xbfb8aa3b, v57
  v_mul_f32 v62, 0xbfb8aa3b, v58
  v_mul_f32 v63, 0xbfb8aa3b, v59
  v_exp_f32 v60, v60
  v_exp_f32 v61, v61
  v_exp_f32 v62, v62
  v_exp_f32 v63, v63
  v_add_f32 v60, 1.0, v60
  v_add_f32 v61, 1.0, v61
  v_add_f32 v62, 1.0, v62
  v_add_f32 v63, 1.0, v63
  v_rcp_f32 v60, v60
  v_rcp_f32 v61, v61
  v_rcp_f32 v62, v62
  v_rcp_f32 v63, v63
  v_mul_f32 v56, v56, v60
  v_mul_f32 v57, v57, v61
  v_mul_f32 v58, v58, v62
  v_mul_f32 v59, v59, v63
  v_cvt_pk_bf16_f32 v16, v56, v56
  v_cvt_pk_bf16_f32 v17, v57, v57
  v_cvt_pk_bf16_f32 v18, v58, v58
  v_cvt_pk_bf16_f32 v19, v59, v59
  v_and_b32 v48, v16, v3
  v_and_b32 v49, v16, v4
  v_and_b32 v50, v16, v5
  v_and_b32 v51, v16, v6
  s_nop 1
  v_mfma_f32_16x16x32_bf16 v[44:47], v[48:51], v[64:67], 0
  v_and_b32 v52, v17, v3
  v_and_b32 v53, v17, v4
  v_and_b32 v54, v17, v5
  v_and_b32 v55, v17, v6
  s_nop 1
  v_mfma_f32_16x16x32_bf16 v[44:47], v[52:55], v[68:71], v[44:47]
  v_and_b32 v48, v18, v3
  v_and_b32 v49, v18, v4
  v_and_b32 v50, v18, v5
  v_and_b32 v51, v18, v6
  s_nop 1
  v_mfma_f32_16x16x32_bf16 v[44:47], v[48:51], v[72:75], v[44:47]
  v_and_b32 v52, v19, v3
  v_and_b32 v53, v19, v4
  v_and_b32 v54, v19, v5
  v_and_b32 v55, v19, v6
  s_nop 1
  v_mfma_f32_16x16x32_bf16 v[44:47], v[52:55], v[76:79], v[44:47]
  s_mov_b64 exec, s[52:53]
  s_nop 6
  ds_write_b128 v8, v[44:47] offset:0
P1MID:
  s_waitcnt lgkmcnt(0)
  s_mov_b64 exec, 1
  ds_add_rtn_u32 v14, v15, v162 offset:12
  s_mov_b64 exec, -1
  s_waitcnt lgkmcnt(0)
  v_readfirstlane_b32 s50, v14
  s_cmp_lg_u32 s50, 7
  s_cbranch_scc1 P1DONE
  v_lshlrev_b32 v12, 2, v1
  v_add_u32 v12, 147584, v12
  ds_read2st64_b32 v[96:97], v12 offset0:0 offset1:1
  ds_read2st64_b32 v[98:99], v12 offset0:2 offset1:3
  ds_read2st64_b32 v[100:101], v12 offset0:4 offset1:5
  ds_read2st64_b32 v[102:103], v12 offset0:6 offset1:7
  s_waitcnt lgkmcnt(0)
  v_pk_add_f32 v[96:97], v[96:97], v[100:101]
  v_pk_add_f32 v[98:99], v[98:99], v[102:103]
  v_pk_add_f32 v[96:97], v[96:97], v[98:99]
  v_add_f32 v44, v96, v97
  v_mov_b32 v45, s5
  v_mov_b32 v47, s5
  v_lshlrev_b32 v12, 3, v1
  v_mov_b32_dpp v46, v44 quad_perm:[1,0,3,2] row_mask:0xf bank_mask:0xf
  s_and_b32 s6, s3, 31
  s_lshl_b32 s6, s6, 12
  s_lshr_b32 s7, s3, 5
  s_lshl_b32 s7, s7, 9
  s_add_u32 s6, s6, s7
  s_add_u32 s6, s6, 4096
  s_mov_b64 exec, s[82:83]
  buffer_store_dwordx4 v[44:47], v12, s[36:39], s6 offen sc1
  s_mov_b64 exec, -1
P1DONE:
  s_waitcnt vmcnt(1)
  v_and_b32 v59, s48, v23
  v_lshlrev_b32 v58, 16, v23
  v_and_b32 v57, s48, v22
  v_lshlrev_b32 v56, 16, v22
  v_mul_f32 v60, 0xbfb8aa3b, v56
  v_mul_f32 v61, 0xbfb8aa3b, v57
  v_mul_f32 v62, 0xbfb8aa3b, v58
  v_mul_f32 v63, 0xbfb8aa3b, v59
  v_exp_f32 v60, v60
  v_exp_f32 v61, v61
  v_exp_f32 v62, v62
  v_exp_f32 v63, v63
  v_add_f32 v60, 1.0, v60
  v_add_f32 v61, 1.0, v61
  v_add_f32 v62, 1.0, v62
  v_add_f32 v63, 1.0, v63
  v_rcp_f32 v60, v60
  v_rcp_f32 v61, v61
  v_rcp_f32 v62, v62
  v_rcp_f32 v63, v63
  v_mul_f32 v56, v56, v60
  v_mul_f32 v57, v57, v61
  v_mul_f32 v58, v58, v62
  v_mul_f32 v59, v59, v63
  v_cvt_pk_bf16_f32 v20, v56, v56
  v_cvt_pk_bf16_f32 v21, v57, v57
  v_cvt_pk_bf16_f32 v22, v58, v58
  v_cvt_pk_bf16_f32 v23, v59, v59
  v_and_b32 v119, s48, v143
  v_lshlrev_b32 v118, 16, v143
  v_and_b32 v117, s48, v142
  v_lshlrev_b32 v116, 16, v142
  v_and_b32 v115, s48, v141
  v_lshlrev_b32 v114, 16, v141
  v_and_b32 v113, s48, v140
  v_lshlrev_b32 v112, 16, v140
  v_and_b32 v111, s48, v139
  v_lshlrev_b32 v110, 16, v139
  v_and_b32 v109, s48, v138
  v_lshlrev_b32 v108, 16, v138
  v_and_b32 v107, s48, v137
  v_lshlrev_b32 v106, 16, v137
  v_and_b32 v105, s48, v136
  v_lshlrev_b32 v104, 16, v136
  v_and_b32 v19, s48, v25
  v_lshlrev_b32 v18, 16, v25
  v_and_b32 v17, s48, v24
  v_lshlrev_b32 v16, 16, v24
  v_pk_add_f32 v[56:57], v[104:105], v[106:107]
  v_pk_add_f32 v[58:59], v[108:109], v[110:111]
  v_pk_add_f32 v[56:57], v[56:57], v[112:113]
  v_pk_add_f32 v[58:59], v[58:59], v[114:115]
  v_pk_add_f32 v[56:57], v[56:57], v[116:117]
  v_pk_add_f32 v[58:59], v[58:59], v[118:119]
  v_pk_add_f32 v[56:57], v[56:57], v[58:59]
  v_add_f32 v60, v56, v57
  s_nop 1
  v_add_f32_dpp v60, v60, v60 quad_perm:[1,0,3,2] row_mask:0xf bank_mask:0xf
  s_nop 1
  v_add_f32_dpp v60, v60, v60 quad_perm:[2,3,0,1] row_mask:0xf bank_mask:0xf
  s_nop 1
  v_add_f32_dpp v60, v60, v60 row_half_mirror row_mask:0xf bank_mask:0xf
  s_nop 1
  v_add_f32_dpp v60, v60, v60 row_mirror row_mask:0xf bank_mask:0xf
  v_mov_b32 v62, v60
  s_nop 1
  v_permlane16_swap_b32 v60, v62
  v_add_f32 v60, v60, v62
  v_mov_b32 v62, v60
  s_nop 1
  v_permlane32_swap_b32 v60, v62
  v_add_f32 v60, v60, v62
  v_mul_f32 v60, 0xba800000, v60
  v_pk_add_f32 v[104:105], v[104:105], v[60:61] op_sel_hi:[1,0]
  v_pk_add_f32 v[106:107], v[106:107], v[60:61] op_sel_hi:[1,0]
  v_pk_add_f32 v[108:109], v[108:109], v[60:61] op_sel_hi:[1,0]
  v_pk_add_f32 v[110:111], v[110:111], v[60:61] op_sel_hi:[1,0]
  v_pk_add_f32 v[112:113], v[112:113], v[60:61] op_sel_hi:[1,0]
  v_pk_add_f32 v[114:115], v[114:115], v[60:61] op_sel_hi:[1,0]
  v_pk_add_f32 v[116:117], v[116:117], v[60:61] op_sel_hi:[1,0]
  v_pk_add_f32 v[118:119], v[118:119], v[60:61] op_sel_hi:[1,0]
  v_pk_mul_f32 v[56:57], v[104:105], v[104:105]
  v_pk_mul_f32 v[58:59], v[106:107], v[106:107]
  v_pk_fma_f32 v[56:57], v[108:109], v[108:109], v[56:57]
  v_pk_fma_f32 v[58:59], v[110:111], v[110:111], v[58:59]
  v_pk_fma_f32 v[56:57], v[112:113], v[112:113], v[56:57]
  v_pk_fma_f32 v[58:59], v[114:115], v[114:115], v[58:59]
  v_pk_fma_f32 v[56:57], v[116:117], v[116:117], v[56:57]
  v_pk_fma_f32 v[58:59], v[118:119], v[118:119], v[58:59]
  v_pk_add_f32 v[56:57], v[56:57], v[58:59]
  v_add_f32 v61, v56, v57
  s_nop 1
  v_add_f32_dpp v61, v61, v61 quad_perm:[1,0,3,2] row_mask:0xf bank_mask:0xf
  s_nop 1
  v_add_f32_dpp v61, v61, v61 quad_perm:[2,3,0,1] row_mask:0xf bank_mask:0xf
  s_nop 1
  v_add_f32_dpp v61, v61, v61 row_half_mirror row_mask:0xf bank_mask:0xf
  s_nop 1
  v_add_f32_dpp v61, v61, v61 row_mirror row_mask:0xf bank_mask:0xf
  v_mov_b32 v62, v61
  s_nop 1
  v_permlane16_swap_b32 v61, v62
  v_add_f32 v61, v61, v62
  v_mov_b32 v62, v61
  s_nop 1
  v_permlane32_swap_b32 v61, v62
  v_add_f32 v61, v61, v62
  v_mul_f32 v61, 0x3a800000, v61
  v_sub_f32 v60, 0, v60
  v_cvt_pk_bf16_f32 v62, v60, v61
  v_lshlrev_b32 v60, 16, v62
  v_and_b32 v61, s48, v62
  v_add_f32 v61, 0x3727c5ac, v61
  v_cvt_pk_bf16_f32 v61, v61, v61
  v_and_b32 v61, s48, v61
  v_sqrt_f32 v61, v61
  s_nop 0
  v_cvt_pk_bf16_f32 v61, v61, v61
  v_and_b32 v61, s48, v61
  v_rcp_f32 v61, v61
  v_sub_f32 v16, v16, v60
  v_sub_f32 v17, v17, v60
  v_sub_f32 v18, v18, v60
  v_sub_f32 v19, v19, v60
  v_cvt_pk_bf16_f32 v56, v16, v17
  v_cvt_pk_bf16_f32 v57, v18, v19
  v_lshlrev_b32 v16, 16, v56
  v_and_b32 v17, s48, v56
  v_lshlrev_b32 v18, 16, v57
  v_and_b32 v19, s48, v57
  v_mul_f32 v16, v16, v61
  v_mul_f32 v17, v17, v61
  v_mul_f32 v18, v18, v61
  v_mul_f32 v19, v19, v61
  v_cvt_pk_bf16_f32 v56, v16, v17
  v_cvt_pk_bf16_f32 v57, v18, v19
  v_lshlrev_b32 v16, 16, v56
  v_and_b32 v17, s48, v56
  v_lshlrev_b32 v18, 16, v57
  v_and_b32 v19, s48, v57
  s_add_u32 s50, s4, 1
L1:
  s_sub_u32 s49, s49, 1
  s_cbranch_scc1 TIMEOUT
  ds_read_b32 v14, v15 offset:0
  s_waitcnt lgkmcnt(0)
  v_cmp_gt_i32 vcc, s50, v14
  s_cbranch_vccnz L1
  v_add_u32 v12, 0, v11
  ds_read_b128 v[64:67], v12 offset:0
  ds_read_b128 v[68:71], v12 offset:1024
  ds_read_b128 v[72:75], v12 offset:2048
  ds_read_b128 v[76:79], v12 offset:3072
  s_waitcnt lgkmcnt(0)
  s_mov_b64 exec, 1
  ds_add_u32 v15, v162 offset:4
  s_mov_b64 exec, -1
  s_lshr_b32 s6, s63, 6
  s_lshl_b32 s6, s6, 12
  s_and_b32 s7, s63, 63
  s_lshl_b32 s7, s7, 3
  s_add_u32 s6, s6, s7
  s_add_u32 s6, s6, 4096
  s_add_u32 s7, s6, 65536
  v_lshlrev_b32 v12, 5, v9
  v_lshl_add_u32 v12, v2, 5, v12
  v_lshlrev_b32 v13, 5, v9
  v_lshl_add_u32 v13, v2, 16, v13
  s_cmp_lg_u32 s4, 0
  s_cbranch_scc1 L5
  s_mov_b64 exec, 0x1
L3:
  buffer_load_dwordx2 v[124:125], v13, s[36:39], s6 offen sc1
  s_waitcnt vmcnt(0)
  v_cmp_ne_u32 vcc, s5, v125
  s_cbranch_vccz L4
  s_sub_u32 s49, s49, 1
  s_cbranch_scc1 TIMEOUT
  s_sleep 1
  s_branch L3
L4:
  s_waitcnt lgkmcnt(0)
  s_mov_b64 exec, 1
  ds_add_u32 v15, v162 offset:64
  s_mov_b64 exec, -1
  s_branch L6
L5:
L7:
  s_sub_u32 s49, s49, 1
  s_cbranch_scc1 TIMEOUT
  s_sleep 1
  ds_read_b32 v14, v15 offset:64
  s_waitcnt lgkmcnt(0)
  v_cmp_gt_i32 vcc, 1, v14
  s_cbranch_vccnz L7
L6:
  s_mov_b64 exec, -1
  buffer_load_dwordx4 v[96:99], v12, s[36:39], s6 offen offset:0
  buffer_load_dwordx4 v[100:103], v12, s[36:39], s6 offen offset:16
  buffer_load_dwordx4 v[104:107], v12, s[36:39], s7 offen offset:0
  buffer_load_dwordx4 v[108:111], v12, s[36:39], s7 offen offset:16
  s_waitcnt vmcnt(0)
  v_xor_b32 v165, s5, v97
  v_bitop3_b32 v165, v165, v99, s5 bitop3:0xf6
  v_bitop3_b32 v165, v165, v101, s5 bitop3:0xf6
  v_bitop3_b32 v165, v165, v103, s5 bitop3:0xf6
  v_bitop3_b32 v165, v165, v105, s5 bitop3:0xf6
  v_bitop3_b32 v165, v165, v107, s5 bitop3:0xf6
  v_bitop3_b32 v165, v165, v109, s5 bitop3:0xf6
  v_bitop3_b32 v165, v165, v111, s5 bitop3:0xf6
  v_cmp_ne_u32 vcc, 0, v165
  s_cbranch_vccz L2
  s_mov_b64 exec, vcc
L8:
  buffer_load_dwordx4 v[96:99], v12, s[36:39], s6 offen offset:0 sc1
  buffer_load_dwordx4 v[100:103], v12, s[36:39], s6 offen offset:16 sc1
  buffer_load_dwordx4 v[104:107], v12, s[36:39], s7 offen offset:0 sc1
  buffer_load_dwordx4 v[108:111], v12, s[36:39], s7 offen offset:16 sc1
  s_waitcnt vmcnt(0)
  v_xor_b32 v165, s5, v97
  v_bitop3_b32 v165, v165, v99, s5 bitop3:0xf6
  v_bitop3_b32 v165, v165, v101, s5 bitop3:0xf6
  v_bitop3_b32 v165, v165, v103, s5 bitop3:0xf6
  v_bitop3_b32 v165, v165, v105, s5 bitop3:0xf6
  v_bitop3_b32 v165, v165, v107, s5 bitop3:0xf6
  v_bitop3_b32 v165, v165, v109, s5 bitop3:0xf6
  v_bitop3_b32 v165, v165, v111, s5 bitop3:0xf6
  v_cmp_ne_u32 vcc, 0, v165
  s_cbranch_vccz L2
  s_mov_b64 exec, vcc
  s_sub_u32 s49, s49, 1
  s_cbranch_scc1 TIMEOUT
  s_sleep 1
  s_branch L8
L2:
  s_mov_b64 exec, -1
  s_waitcnt lgkmcnt(0)
  s_mov_b64 exec, 1
  ds_add_u32 v15, v162 offset:52
  s_mov_b64 exec, -1
  v_add_f32_dpp v96, v96, v96 quad_perm:[1,0,3,2] row_mask:0xf bank_mask:0xf
  v_add_f32_dpp v98, v98, v98 quad_perm:[1,0,3,2] row_mask:0xf bank_mask:0xf
  v_add_f32_dpp v100, v100, v100 quad_perm:[1,0,3,2] row_mask:0xf bank_mask:0xf
  v_add_f32_dpp v102, v102, v102 quad_perm:[1,0,3,2] row_mask:0xf bank_mask:0xf
  v_add_f32_dpp v104, v104, v104 quad_perm:[1,0,3,2] row_mask:0xf bank_mask:0xf
  v_add_f32_dpp v106, v106, v106 quad_perm:[1,0,3,2] row_mask:0xf bank_mask:0xf
  v_add_f32_dpp v108, v108, v108 quad_perm:[1,0,3,2] row_mask:0xf bank_mask:0xf
  v_add_f32_dpp v110, v110, v110 quad_perm:[1,0,3,2] row_mask:0xf bank_mask:0xf
  v_add_f32_dpp v96, v96, v96 quad_perm:[2,3,0,1] row_mask:0xf bank_mask:0xf
  v_add_f32_dpp v98, v98, v98 quad_perm:[2,3,0,1] row_mask:0xf bank_mask:0xf
  v_add_f32_dpp v100, v100, v100 quad_perm:[2,3,0,1] row_mask:0xf bank_mask:0xf
  v_add_f32_dpp v102, v102, v102 quad_perm:[2,3,0,1] row_mask:0xf bank_mask:0xf
  v_add_f32_dpp v104, v104, v104 quad_perm:[2,3,0,1] row_mask:0xf bank_mask:0xf
  v_add_f32_dpp v106, v106, v106 quad_perm:[2,3,0,1] row_mask:0xf bank_mask:0xf
  v_add_f32_dpp v108, v108, v108 quad_perm:[2,3,0,1] row_mask:0xf bank_mask:0xf
  v_add_f32_dpp v110, v110, v110 quad_perm:[2,3,0,1] row_mask:0xf bank_mask:0xf
  v_add_f32_dpp v96, v96, v96 row_half_mirror row_mask:0xf bank_mask:0xf
  v_add_f32_dpp v98, v98, v98 row_half_mirror row_mask:0xf bank_mask:0xf
  v_add_f32_dpp v100, v100, v100 row_half_mirror row_mask:0xf bank_mask:0xf
  v_add_f32_dpp v102, v102, v102 row_half_mirror row_mask:0xf bank_mask:0xf
  v_add_f32_dpp v104, v104, v104 row_half_mirror row_mask:0xf bank_mask:0xf
  v_add_f32_dpp v106, v106, v106 row_half_mirror row_mask:0xf bank_mask:0xf
  v_add_f32_dpp v108, v108, v108 row_half_mirror row_mask:0xf bank_mask:0xf
  v_add_f32_dpp v110, v110, v110 row_half_mirror row_mask:0xf bank_mask:0xf
  v_cvt_pk_bf16_f32 v56, v96, v98
  v_cvt_pk_bf16_f32 v57, v100, v102
  v_cvt_pk_bf16_f32 v58, v104, v106
  v_cvt_pk_bf16_f32 v59, v108, v110
  v_lshlrev_b32 v96, 16, v56
  v_and_b32 v98, s48, v56
  v_lshlrev_b32 v100, 16, v57
  v_and_b32 v102, s48, v57
  v_lshlrev_b32 v104, 16, v58
  v_and_b32 v106, s48, v58
  v_lshlrev_b32 v108, 16, v59
  v_and_b32 v110, s48, v59
  v_add_f32 v104, 1.0, v104
  v_add_f32 v106, 1.0, v106
  v_add_f32 v108, 1.0, v108
  v_add_f32 v110, 1.0, v110
  v_cvt_pk_bf16_f32 v56, v104, v106
  v_cvt_pk_bf16_f32 v57, v108, v110
  v_lshlrev_b32 v104, 16, v56
  v_and_b32 v106, s48, v56
  v_lshlrev_b32 v108, 16, v57
  v_and_b32 v110, s48, v57
  v_mul_f32 v16, v16, v104
  v_mul_f32 v17, v17, v106
  v_mul_f32 v18, v18, v108
  v_mul_f32 v19, v19, v110
  v_cvt_pk_bf16_f32 v56, v16, v17
  v_cvt_pk_bf16_f32 v57, v18, v19
  v_lshlrev_b32 v16, 16, v56
  v_and_b32 v17, s48, v56
  v_lshlrev_b32 v18, 16, v57
  v_and_b32 v19, s48, v57
  v_add_f32 v16, v16, v96
  v_add_f32 v17, v17, v98
  v_add_f32 v18, v18, v100
  v_add_f32 v19, v19, v102
  v_cvt_pk_bf16_f32 v56, v16, v16
  v_cvt_pk_bf16_f32 v57, v17, v17
  v_cvt_pk_bf16_f32 v58, v18, v18
  v_cvt_pk_bf16_f32 v59, v19, v19
  v_and_b32 v48, v56, v3
  v_and_b32 v49, v56, v4
  v_and_b32 v50, v56, v5
  v_and_b32 v51, v56, v6
  s_nop 1
  v_mfma_f32_16x16x32_bf16 v[44:47], v[48:51], v[64:67], 0
  v_and_b32 v52, v57, v3
  v_and_b32 v53, v57, v4
  v_and_b32 v54, v57, v5
  v_and_b32 v55, v57, v6
  s_nop 1
  v_mfma_f32_16x16x32_bf16 v[44:47], v[52:55], v[68:71], v[44:47]
  v_and_b32 v48, v58, v3
  v_and_b32 v49, v58, v4
  v_and_b32 v50, v58, v5
  v_and_b32 v51, v58, v6
  s_nop 1
  v_mfma_f32_16x16x32_bf16 v[44:47], v[48:51], v[72:75], v[44:47]
  v_and_b32 v52, v59, v3
  v_and_b32 v53, v59, v4
  v_and_b32 v54, v59, v5
  v_and_b32 v55, v59, v6
  s_nop 1
  v_mfma_f32_16x16x32_bf16 v[44:47], v[52:55], v[76:79], v[44:47]
  s_mov_b64 exec, s[52:53]
  s_nop 6
  ds_write_b128 v8, v[44:47] offset:4096
  s_waitcnt lgkmcnt(0)
  s_mov_b64 exec, 1
  ds_add_rtn_u32 v14, v15, v162 offset:16
  s_mov_b64 exec, -1
  s_waitcnt lgkmcnt(0)
  v_readfirstlane_b32 s50, v14
  s_cmp_lg_u32 s50, 7
  s_cbranch_scc1 P2DONE
  v_lshlrev_b32 v12, 2, v1
  v_add_u32 v12, 151680, v12
  ds_read2st64_b32 v[96:97], v12 offset0:0 offset1:1
  ds_read2st64_b32 v[98:99], v12 offset0:2 offset1:3
  ds_read2st64_b32 v[100:101], v12 offset0:4 offset1:5
  ds_read2st64_b32 v[102:103], v12 offset0:6 offset1:7
  ds_read2st64_b32 v[104:105], v12 offset0:8 offset1:9
  ds_read2st64_b32 v[106:107], v12 offset0:10 offset1:11
  ds_read2st64_b32 v[108:109], v12 offset0:12 offset1:13
  ds_read2st64_b32 v[110:111], v12 offset0:14 offset1:15
  s_waitcnt lgkmcnt(0)
  v_pk_add_f32 v[96:97], v[96:97], v[104:105]
  v_pk_add_f32 v[98:99], v[98:99], v[106:107]
  v_pk_add_f32 v[100:101], v[100:101], v[108:109]
  v_pk_add_f32 v[102:103], v[102:103], v[110:111]
  v_pk_add_f32 v[96:97], v[96:97], v[100:101]
  v_pk_add_f32 v[98:99], v[98:99], v[102:103]
  v_pk_add_f32 v[96:97], v[96:97], v[98:99]
  v_add_f32 v44, v96, v97
  v_mov_b32 v45, s5
  v_mov_b32 v47, s5
  v_lshlrev_b32 v12, 3, v1
  v_mov_b32_dpp v46, v44 quad_perm:[1,0,3,2] row_mask:0xf bank_mask:0xf
  s_lshl_b32 s6, s54, 11
  s_lshl_b32 s7, s55, 9
  s_add_u32 s6, s6, s7
  s_add_u32 s6, s6, 135168
  s_mov_b64 exec, s[82:83]
  buffer_store_dwordx4 v[44:47], v12, s[36:39], s6 offen sc1
  s_mov_b64 exec, -1
P2DONE:
  s_cmp_ge_u32 s4, 4
  s_cbranch_scc1 NOK
  s_add_u32 s50, s4, 17
L9:
  s_sub_u32 s49, s49, 1
  s_cbranch_scc1 TIMEOUT
  ds_read_b32 v14, v15 offset:0
  s_waitcnt lgkmcnt(0)
  v_cmp_gt_i32 vcc, s50, v14
  s_cbranch_vccnz L9
  v_and_b32 v13, 15, v1
  v_xor_b32 v12, v164, v13
  v_lshlrev_b32 v12, 4, v12
  v_lshl_add_u32 v12, v13, 8, v12
  s_lshl_b32 s6, s4, 12
  s_add_u32 s6, s6, 32768
  v_add_u32 v12, s6, v12
  v_xor_b32 v13, 0, v12
  ds_read_b128 v[136:139], v13
  v_xor_b32 v13, 64, v12
  ds_read_b128 v[140:143], v13
  v_xor_b32 v13, 128, v12
  ds_read_b128 v[144:147], v13
  v_xor_b32 v13, 192, v12
  ds_read_b128 v[148:151], v13
  s_waitcnt lgkmcnt(0)
  s_mov_b64 exec, 1
  ds_add_u32 v15, v162 offset:4
  s_mov_b64 exec, -1
NOK:
  s_mov_b32 s50, 24
L10:
  s_sub_u32 s49, s49, 1
  s_cbranch_scc1 TIMEOUT
  ds_read_b32 v14, v15 offset:0
  s_waitcnt lgkmcnt(0)
  v_cmp_gt_i32 vcc, s50, v14
  s_cbranch_vccnz L10
  v_bfe_u32 v12, v1, 2, 2
  v_lshl_add_u32 v13, v164, 3, v12
  v_and_b32 v14, 15, v13
  v_bfe_u32 v12, v1, 1, 1
  s_lshl_b32 s6, s4, 1
  v_add_u32 v12, s6, v12
  v_xor_b32 v12, v12, v14
  v_lshlrev_b32 v12, 4, v12
  v_lshl_add_u32 v12, v13, 8, v12
  v_and_b32 v13, 1, v1
  v_lshl_add_u32 v12, v13, 3, v12
  v_add_u32 v12, 65536, v12
  v_xor_b32 v13, 64, v12
  ds_read_b64_tr_b16 v[128:129], v12
  ds_read_b64_tr_b16 v[130:131], v13 offset:1024
  ds_read_b64_tr_b16 v[132:133], v12 offset:8192
  ds_read_b64_tr_b16 v[134:135], v13 offset:9216
  s_lshl_b32 s6, s55, 15
  s_lshl_b32 s7, s4, 12
  s_add_u32 s6, s6, s7
  s_add_u32 s6, s6, 135168
  v_and_b32 v13, 31, v1
  v_lshlrev_b32 v13, 4, v13
  v_lshrrev_b32 v12, 5, v1
  v_lshl_add_u32 v12, v12, 11, v13
  v_lshlrev_b32 v13, 9, v1
  s_cmp_lg_u32 s4, 0
  s_cbranch_scc1 L14
  s_mov_b64 exec, 0x1
L12:
  buffer_load_dwordx2 v[124:125], v13, s[36:39], s6 offen sc1
  s_waitcnt vmcnt(0)
  v_cmp_ne_u32 vcc, s5, v125
  s_cbranch_vccz L13
  s_sub_u32 s49, s49, 1
  s_cbranch_scc1 TIMEOUT
  s_sleep 1
  s_branch L12
L13:
  s_waitcnt lgkmcnt(0)
  s_mov_b64 exec, 1
  ds_add_u32 v15, v162 offset:68
  s_mov_b64 exec, -1
  s_branch L15
L14:
L16:
  s_sub_u32 s49, s49, 1
  s_cbranch_scc1 TIMEOUT
  s_sleep 1
  ds_read_b32 v14, v15 offset:68
  s_waitcnt lgkmcnt(0)
  v_cmp_gt_i32 vcc, 1, v14
  s_cbranch_vccnz L16
L15:
  s_mov_b64 exec, -1
  buffer_load_dwordx4 v[96:99], v12, s[36:39], s6 offen offset:0
  buffer_load_dwordx4 v[100:103], v12, s[36:39], s6 offen offset:512
  buffer_load_dwordx4 v[104:107], v12, s[36:39], s6 offen offset:1024
  buffer_load_dwordx4 v[108:111], v12, s[36:39], s6 offen offset:1536
  s_waitcnt vmcnt(0)
  v_xor_b32 v165, s5, v97
  v_bitop3_b32 v165, v165, v99, s5 bitop3:0xf6
  v_bitop3_b32 v165, v165, v101, s5 bitop3:0xf6
  v_bitop3_b32 v165, v165, v103, s5 bitop3:0xf6
  v_bitop3_b32 v165, v165, v105, s5 bitop3:0xf6
  v_bitop3_b32 v165, v165, v107, s5 bitop3:0xf6
  v_bitop3_b32 v165, v165, v109, s5 bitop3:0xf6
  v_bitop3_b32 v165, v165, v111, s5 bitop3:0xf6
  v_cmp_ne_u32 vcc, 0, v165
  s_cbranch_vccz L11
  s_mov_b64 exec, vcc
L17:
  buffer_load_dwordx4 v[96:99], v12, s[36:39], s6 offen offset:0 sc1
  buffer_load_dwordx4 v[100:103], v12, s[36:39], s6 offen offset:512 sc1
  buffer_load_dwordx4 v[104:107], v12, s[36:39], s6 offen offset:1024 sc1
  buffer_load_dwordx4 v[108:111], v12, s[36:39], s6 offen offset:1536 sc1
  s_waitcnt vmcnt(0)
  v_xor_b32 v165, s5, v97
  v_bitop3_b32 v165, v165, v99, s5 bitop3:0xf6
  v_bitop3_b32 v165, v165, v101, s5 bitop3:0xf6
  v_bitop3_b32 v165, v165, v103, s5 bitop3:0xf6
  v_bitop3_b32 v165, v165, v105, s5 bitop3:0xf6
  v_bitop3_b32 v165, v165, v107, s5 bitop3:0xf6
  v_bitop3_b32 v165, v165, v109, s5 bitop3:0xf6
  v_bitop3_b32 v165, v165, v111, s5 bitop3:0xf6
  v_cmp_ne_u32 vcc, 0, v165
  s_cbranch_vccz L11
  s_mov_b64 exec, vcc
  s_sub_u32 s49, s49, 1
  s_cbranch_scc1 TIMEOUT
  s_sleep 1
  s_branch L17
L11:
  s_mov_b64 exec, -1
  s_waitcnt lgkmcnt(0)
  s_mov_b64 exec, 1
  ds_add_u32 v15, v162 offset:56
  s_mov_b64 exec, -1
  v_add_f32 v96, v96, v100
  v_add_f32 v98, v98, v102
  v_add_f32 v104, v104, v108
  v_add_f32 v106, v106, v110
  v_add_f32 v96, v96, v104
  v_add_f32 v98, v98, v106
  s_mul_i32 s6, s4, 272
  s_add_u32 s6, s6, 155776
  v_lshl_add_u32 v12, v1, 2, s6
  v_cvt_pk_bf16_f32 v96, v96, v98
  ds_write_b32 v12, v96
  s_waitcnt lgkmcnt(0)
  s_mov_b64 exec, 1
  ds_add_u32 v15, v162 offset:20
  s_mov_b64 exec, -1
  v_and_b32 v13, 7, v1
  v_mul_u32_u24 v13, 272, v13
  s_cmp_ge_u32 s4, 4
  s_cbranch_scc1 NOQK
  v_lshl_add_u32 v12, v164, 4, v13
  v_add_u32 v12, 155776, v12
L18:
  s_sub_u32 s49, s49, 1
  s_cbranch_scc1 TIMEOUT
  ds_read_b32 v14, v15 offset:20
  s_waitcnt lgkmcnt(0)
  v_cmp_gt_i32 vcc, 8, v14
  s_cbranch_vccnz L18
  ds_read_b128 v[96:99], v12 offset:0
  ds_read_b128 v[100:103], v12 offset:64
  ds_read_b128 v[104:107], v12 offset:128
  ds_read_b128 v[108:111], v12 offset:192
  s_waitcnt lgkmcnt(3)
  v_mfma_f32_16x16x32_bf16 v[44:47], v[136:139], v[96:99], 0
  s_waitcnt lgkmcnt(2)
  v_mfma_f32_16x16x32_bf16 v[44:47], v[140:143], v[100:103], v[44:47]
  s_waitcnt lgkmcnt(1)
  v_mfma_f32_16x16x32_bf16 v[44:47], v[144:147], v[104:107], v[44:47]
  s_waitcnt lgkmcnt(0)
  v_mfma_f32_16x16x32_bf16 v[44:47], v[148:151], v[108:111], v[44:47]
  s_lshl_b32 s6, s4, 6
  s_add_u32 s6, s6, 2176
  v_add_u32 v12, s6, v12
  s_nop 4
  v_cvt_pk_bf16_f32 v56, v44, v45
  v_cvt_pk_bf16_f32 v57, v46, v47
  v_lshlrev_b32 v44, 16, v56
  v_and_b32 v45, s48, v56
  v_lshlrev_b32 v46, 16, v57
  v_and_b32 v47, s48, v57
  v_mul_f32 v44, 0x3db504f3, v44
  v_mul_f32 v45, 0x3db504f3, v45
  v_mul_f32 v46, 0x3db504f3, v46
  v_mul_f32 v47, 0x3db504f3, v47
  v_cvt_pk_bf16_f32 v56, v44, v45
  v_cvt_pk_bf16_f32 v57, v46, v47
  v_lshlrev_b32 v44, 16, v56
  v_and_b32 v45, s48, v56
  v_lshlrev_b32 v46, 16, v57
  v_and_b32 v47, s48, v57
  s_mov_b32 exec_lo, s52
  s_mov_b32 exec_hi, s52
  ds_write_b128 v12, v[44:47]
  s_mov_b64 exec, -1
  s_waitcnt lgkmcnt(0)
  s_mov_b64 exec, 1
  ds_add_u32 v15, v162 offset:24
  s_mov_b64 exec, -1
NOQK:
  v_lshl_add_u32 v12, v164, 5, v13
  v_add_u32 v12, 157952, v12
L19:
  s_sub_u32 s49, s49, 1
  s_cbranch_scc1 TIMEOUT
  ds_read_b32 v14, v15 offset:24
  s_waitcnt lgkmcnt(0)
  v_cmp_gt_i32 vcc, 4, v14
  s_cbranch_vccnz L19
  ds_read_b128 v[96:99], v12 offset:0
  ds_read_b128 v[100:103], v12 offset:16
  ds_read_b128 v[104:107], v12 offset:128
  ds_read_b128 v[108:111], v12 offset:144
  s_waitcnt lgkmcnt(0)
  v_max3_f32 v56, v96, v97, v98
  v_max3_f32 v56, v56, v99, v100
  v_max3_f32 v56, v56, v101, v102
  v_max3_f32 v56, v56, v103, v104
  v_max3_f32 v56, v56, v105, v106
  v_max3_f32 v56, v56, v107, v108
  v_max3_f32 v56, v56, v109, v110
  v_max_f32 v56, v56, v111
  v_mov_b32 v58, v56
  s_nop 1
  v_permlane16_swap_b32 v56, v58
  v_max_f32 v56, v56, v58
  v_mov_b32 v58, v56
  s_nop 1
  v_permlane32_swap_b32 v56, v58
  v_max_f32 v56, v56, v58
  v_mul_f32 v57, 0xbfb8aa3b, v56
  s_mov_b32 s6, 0x3fb8aa3b
  v_fma_f32 v96, v96, s6, v57
  v_fma_f32 v97, v97, s6, v57
  v_fma_f32 v98, v98, s6, v57
  v_fma_f32 v99, v99, s6, v57
  v_fma_f32 v100, v100, s6, v57
  v_fma_f32 v101, v101, s6, v57
  v_fma_f32 v102, v102, s6, v57
  v_fma_f32 v103, v103, s6, v57
  v_fma_f32 v104, v104, s6, v57
  v_fma_f32 v105, v105, s6, v57
  v_fma_f32 v106, v106, s6, v57
  v_fma_f32 v107, v107, s6, v57
  v_fma_f32 v108, v108, s6, v57
  v_fma_f32 v109, v109, s6, v57
  v_fma_f32 v110, v110, s6, v57
  v_fma_f32 v111, v111, s6, v57
  v_exp_f32 v96, v96
  v_exp_f32 v97, v97
  v_exp_f32 v98, v98
  v_exp_f32 v99, v99
  v_exp_f32 v100, v100
  v_exp_f32 v101, v101
  v_exp_f32 v102, v102
  v_exp_f32 v103, v103
  v_exp_f32 v104, v104
  v_exp_f32 v105, v105
  v_exp_f32 v106, v106
  v_exp_f32 v107, v107
  v_exp_f32 v108, v108
  v_exp_f32 v109, v109
  v_exp_f32 v110, v110
  v_exp_f32 v111, v111
  v_cvt_pk_bf16_f32 v112, v96, v97
  v_cvt_pk_bf16_f32 v113, v98, v99
  v_cvt_pk_bf16_f32 v114, v100, v101
  v_cvt_pk_bf16_f32 v115, v102, v103
  v_cvt_pk_bf16_f32 v116, v104, v105
  v_cvt_pk_bf16_f32 v117, v106, v107
  v_cvt_pk_bf16_f32 v118, v108, v109
  v_cvt_pk_bf16_f32 v119, v110, v111
  v_mfma_f32_16x16x32_bf16 v[44:47], v[128:131], v[112:115], 0
  s_nop 0
  v_mfma_f32_16x16x32_bf16 v[44:47], v[132:135], v[116:119], v[44:47]
  s_lshl_b32 s6, s55, 17
  s_lshl_b32 s7, s54, 7
  s_add_u32 s6, s6, s7
  s_lshr_b32 s7, s4, 2
  s_lshl_b32 s7, s7, 13
  s_add_u32 s6, s6, s7
  s_and_b32 s7, s4, 3
  s_lshl_b32 s7, s7, 5
  s_add_u32 s6, s6, s7
  s_add_u32 s6, s6, 266240
  v_lshlrev_b32 v12, 10, v9
  v_lshl_add_u32 v12, v164, 3, v12
  s_mov_b32 s50, 0xff
  s_mov_b32 s51, 0xff
  v_cvt_pk_bf16_f32 v44, v44, v45
  v_cvt_pk_bf16_f32 v45, v46, v47
  v_mov_b32 v46, v44
  v_mov_b32 v47, v45
  s_nop 0
  v_permlane16_swap_b32 v44, v46
  v_permlane16_swap_b32 v45, v47
  s_mov_b64 exec, s[50:51]
  buffer_store_dwordx4 v[44:47], v12, s[36:39], s6 offen sc1
  s_mov_b64 exec, -1
  s_cmp_lg_u32 s4, 0
  s_cbranch_scc1 NOML
  v_pk_add_f32 v[96:97], v[96:97], v[104:105]
  v_pk_add_f32 v[98:99], v[98:99], v[106:107]
  v_pk_add_f32 v[100:101], v[100:101], v[108:109]
  v_pk_add_f32 v[102:103], v[102:103], v[110:111]
  v_pk_add_f32 v[96:97], v[96:97], v[100:101]
  v_pk_add_f32 v[98:99], v[98:99], v[102:103]
  v_pk_add_f32 v[96:97], v[96:97], v[98:99]
  v_add_f32 v57, v96, v97
  v_mov_b32 v58, v57
  s_nop 1
  v_permlane16_swap_b32 v57, v58
  v_add_f32 v57, v57, v58
  v_mov_b32 v58, v57
  s_nop 1
  v_permlane32_swap_b32 v57, v58
  v_add_f32 v57, v57, v58
  s_lshl_b32 s6, s55, 12
  s_lshl_b32 s7, s54, 3
  s_add_u32 s6, s6, s7
  s_add_u32 s6, s6, 1314816
  v_lshlrev_b32 v12, 9, v1
  s_mov_b64 exec, 0xff
  buffer_store_dwordx2 v[56:57], v12, s[36:39], s6 offen sc1
  s_mov_b64 exec, -1
NOML:
  s_add_u32 s50, s4, 9
L20:
  s_sub_u32 s49, s49, 1
  s_cbranch_scc1 TIMEOUT
  ds_read_b32 v14, v15 offset:0
  s_waitcnt lgkmcnt(0)
  v_cmp_gt_i32 vcc, s50, v14
  s_cbranch_vccnz L20
  v_add_u32 v12, 81920, v11
  ds_read_b128 v[64:67], v12 offset:0
  ds_read_b128 v[68:71], v12 offset:1024
  ds_read_b128 v[72:75], v12 offset:2048
  ds_read_b128 v[76:79], v12 offset:3072
  s_waitcnt lgkmcnt(0)
  s_mov_b64 exec, 1
  ds_add_u32 v15, v162 offset:8
  s_mov_b64 exec, -1
  v_and_b32 v48, v20, v3
  v_and_b32 v49, v20, v4
  v_and_b32 v50, v20, v5
  v_and_b32 v51, v20, v6
  s_nop 1
  v_mfma_f32_16x16x32_bf16 v[44:47], v[48:51], v[64:67], 0
  v_and_b32 v52, v21, v3
  v_and_b32 v53, v21, v4
  v_and_b32 v54, v21, v5
  v_and_b32 v55, v21, v6
  s_nop 1
  v_mfma_f32_16x16x32_bf16 v[44:47], v[52:55], v[68:71], v[44:47]
  v_and_b32 v48, v22, v3
  v_and_b32 v49, v22, v4
  v_and_b32 v50, v22, v5
  v_and_b32 v51, v22, v6
  s_nop 1
  v_mfma_f32_16x16x32_bf16 v[44:47], v[48:51], v[72:75], v[44:47]
  v_and_b32 v52, v23, v3
  v_and_b32 v53, v23, v4
  v_and_b32 v54, v23, v5
  v_and_b32 v55, v23, v6
  s_nop 1
  v_mfma_f32_16x16x32_bf16 v[44:47], v[52:55], v[76:79], v[44:47]
  s_mov_b64 exec, s[52:53]
  s_nop 6
  ds_write_b128 v8, v[44:47] offset:0
  s_waitcnt lgkmcnt(0)
  s_mov_b64 exec, 1
  ds_add_rtn_u32 v14, v15, v162 offset:28
  s_mov_b64 exec, -1
  s_waitcnt lgkmcnt(0)
  v_readfirstlane_b32 s50, v14
  s_cmp_lg_u32 s50, 7
  s_cbranch_scc1 M2DONE
  ds_read_b128 v[96:99], v10 offset:0
  ds_read_b128 v[100:103], v10 offset:256
  ds_read_b128 v[104:107], v10 offset:512
  ds_read_b128 v[108:111], v10 offset:768
  s_waitcnt lgkmcnt(0)
  v_pk_add_f32 v[96:97], v[96:97], v[100:101]
  v_pk_add_f32 v[98:99], v[98:99], v[102:103]
  v_pk_add_f32 v[104:105], v[104:105], v[108:109]
  v_pk_add_f32 v[106:107], v[106:107], v[110:111]
  v_pk_add_f32 v[44:45], v[96:97], v[104:105]
  v_pk_add_f32 v[46:47], v[98:99], v[106:107]
  v_mov_b32 v96, v44
  v_mov_b32 v97, v45
  v_mov_b32 v98, v46
  v_mov_b32 v99, v47
  v_permlane16_swap_b32 v44, v96
  v_permlane16_swap_b32 v45, v97
  v_permlane16_swap_b32 v46, v98
  v_permlane16_swap_b32 v47, v99
  v_add_f32 v44, v44, v96
  v_add_f32 v45, v45, v97
  v_add_f32 v46, v46, v98
  v_add_f32 v47, v47, v99
  v_mov_b32 v96, v44
  v_mov_b32 v97, v45
  v_mov_b32 v98, v46
  v_mov_b32 v99, v47
  v_permlane32_swap_b32 v44, v96
  v_permlane32_swap_b32 v45, v97
  v_permlane32_swap_b32 v46, v98
  v_permlane32_swap_b32 v47, v99
  v_add_f32 v44, v44, v96
  v_add_f32 v45, v45, v97
  v_add_f32 v46, v46, v98
  v_add_f32 v47, v47, v99
  s_lshl_b32 s6, s55, 14
  s_lshl_b32 s7, s54, 8
  s_add_u32 s6, s6, s7
  s_add_u32 s6, s6, 1347584
  s_mov_b64 exec, 0xffff
  buffer_store_dwordx4 v[44:47], v163, s[36:39], s6 offen sc1
  s_mov_b64 exec, -1
M2DONE:
  s_add_u32 s50, s4, 25
L21:
  s_sub_u32 s49, s49, 1
  s_cbranch_scc1 TIMEOUT
  ds_read_b32 v14, v15 offset:0
  s_waitcnt lgkmcnt(0)
  v_cmp_gt_i32 vcc, s50, v14
  s_cbranch_vccnz L21
  v_add_u32 v12, 114688, v11
  ds_read_b128 v[64:67], v12 offset:0
  ds_read_b128 v[68:71], v12 offset:1024
  ds_read_b128 v[72:75], v12 offset:2048
  ds_read_b128 v[76:79], v12 offset:3072
  s_lshr_b32 s6, s56, 1
  s_lshl_b32 s6, s6, 12
  s_lshl_b32 s7, s57, 8
  s_add_u32 s6, s6, s7
  s_and_b32 s7, s56, 1
  s_lshl_b32 s7, s7, 7
  s_add_u32 s6, s6, s7
  s_add_u32 s64, s6, 1413120
  s_mov_b32 s6, s64
  s_and_b32 s6, s4, 3
  s_lshl_b32 s7, s57, 2
  s_add_u32 s6, s6, s7
  s_lshr_b32 s7, s6, 1
  s_lshl_b32 s7, s7, 9
  s_add_u32 s72, s7, 1314816
  s_lshr_b32 s7, s4, 2
  v_and_b32 v13, 1, v1
  v_xor_b32 v13, s7, v13
  v_lshlrev_b32 v13, 8, v13
  v_lshl_add_u32 v13, v2, 5, v13
  s_lshl_b32 s6, s6, 1
  s_add_u32 s6, s6, s7
  s_lshl_b32 s6, s6, 12
  s_add_u32 s65, s6, 266240
  v_lshl_add_u32 v12, v2, 9, v9
  s_lshr_b32 s6, s4, 1
  s_lshl_b32 s6, s6, 9
  s_and_b32 s7, s4, 1
  s_lshl_b32 s7, s7, 7
  s_add_u32 s6, s6, s7
  s_add_u32 s6, s6, 151680
  v_lshl_add_u32 v166, v2, 4, s6
  s_lshl_b32 s66, s56, 8
  s_add_u32 s66, s66, 1347584
  v_lshl_add_u32 v167, v164, 14, v163
  v_lshlrev_b32 v123, 3, v1
  s_lshl_b32 s62, s58, 9
  s_lshl_b32 s6, s4, 6
  s_add_u32 s62, s62, s6
  s_lshl_b32 s62, s62, 2
  s_add_u32 s67, s62, 1351680
  v_and_b32 v36, 3, v1
  v_lshlrev_b32 v36, 14, v36
  v_bfe_u32 v37, v1, 2, 1
  v_lshl_add_u32 v36, v37, 12, v36
  v_lshl_add_u32 v36, v2, 4, v36
  s_cmp_lg_u32 s4, 0
  s_cbranch_scc1 L25
  s_mov_b64 exec, 0x1
L23:
  buffer_load_dwordx2 v[124:125], v12, s[36:39], s65 offen sc1
  s_waitcnt vmcnt(0)
  v_max_u32 v165, v124, v125
  v_cmp_eq_u32 vcc, -1, v165
  s_cbranch_vccz L24
  s_sub_u32 s49, s49, 1
  s_cbranch_scc1 TIMEOUT
  s_sleep 1
  s_branch L23
L24:
  s_waitcnt lgkmcnt(0)
  s_mov_b64 exec, 1
  ds_add_u32 v15, v162 offset:72
  s_mov_b64 exec, -1
  s_branch L26
L25:
L27:
  s_sub_u32 s49, s49, 1
  s_cbranch_scc1 TIMEOUT
  s_sleep 1
  ds_read_b32 v14, v15 offset:72
  s_waitcnt lgkmcnt(0)
  v_cmp_gt_i32 vcc, 1, v14
  s_cbranch_vccnz L27
L26:
  s_mov_b64 exec, -1
  buffer_load_dwordx4 v[96:99], v12, s[36:39], s65 offen offset:0
  buffer_load_dwordx4 v[100:103], v12, s[36:39], s65 offen offset:128
  buffer_load_dwordx4 v[104:107], v12, s[36:39], s65 offen offset:256
  buffer_load_dwordx4 v[108:111], v12, s[36:39], s65 offen offset:384
  buffer_load_dwordx4 v[112:115], v13, s[36:39], s72 offen offset:0
  buffer_load_dwordx4 v[116:119], v13, s[36:39], s72 offen offset:16
  s_waitcnt vmcnt(0)
  v_max3_u32 v165, v96, v97, v98
  v_max3_u32 v165, v165, v99, v100
  v_max3_u32 v165, v165, v101, v102
  v_max3_u32 v165, v165, v103, v104
  v_max3_u32 v165, v165, v105, v106
  v_max3_u32 v165, v165, v107, v108
  v_max3_u32 v165, v165, v109, v110
  v_max3_u32 v165, v165, v111, v112
  v_max3_u32 v165, v165, v113, v114
  v_max3_u32 v165, v165, v115, v116
  v_max3_u32 v165, v165, v117, v118
  v_max_u32 v165, v165, v119
  v_cmp_eq_u32 vcc, -1, v165
  s_cbranch_vccz L22
  s_mov_b64 exec, vcc
L28:
  buffer_load_dwordx4 v[96:99], v12, s[36:39], s65 offen offset:0 sc1
  buffer_load_dwordx4 v[100:103], v12, s[36:39], s65 offen offset:128 sc1
  buffer_load_dwordx4 v[104:107], v12, s[36:39], s65 offen offset:256 sc1
  buffer_load_dwordx4 v[108:111], v12, s[36:39], s65 offen offset:384 sc1
  buffer_load_dwordx4 v[112:115], v13, s[36:39], s72 offen offset:0 sc1
  buffer_load_dwordx4 v[116:119], v13, s[36:39], s72 offen offset:16 sc1
  s_waitcnt vmcnt(0)
  v_max3_u32 v165, v96, v97, v98
  v_max3_u32 v165, v165, v99, v100
  v_max3_u32 v165, v165, v101, v102
  v_max3_u32 v165, v165, v103, v104
  v_max3_u32 v165, v165, v105, v106
  v_max3_u32 v165, v165, v107, v108
  v_max3_u32 v165, v165, v109, v110
  v_max3_u32 v165, v165, v111, v112
  v_max3_u32 v165, v165, v113, v114
  v_max3_u32 v165, v165, v115, v116
  v_max3_u32 v165, v165, v117, v118
  v_max_u32 v165, v165, v119
  v_cmp_eq_u32 vcc, -1, v165
  s_cbranch_vccz L22
  s_mov_b64 exec, vcc
  s_sub_u32 s49, s49, 1
  s_cbranch_scc1 TIMEOUT
  s_sleep 1
  s_branch L28
L22:
  s_mov_b64 exec, -1
  s_waitcnt lgkmcnt(0)
  s_mov_b64 exec, 1
  ds_add_u32 v15, v162 offset:60
  s_mov_b64 exec, -1
  buffer_load_dwordx4 v[24:27], v167, s[36:39], s66 offen offset:0
  buffer_load_dwordx4 v[28:31], v36, s[36:39], s67 offen offset:0
  buffer_load_dwordx4 v[32:35], v36, s[36:39], s67 offen offset:128
  v_max3_f32 v58, v112, v114, v116
  v_max_f32 v58, v58, v118
  s_nop 1
  v_max_f32_dpp v58, v58, v58 quad_perm:[1,0,3,2] row_mask:0xf bank_mask:0xf
  s_nop 1
  v_max_f32_dpp v58, v58, v58 row_ror:8 row_mask:0xf bank_mask:0xf
  v_mov_b32 v59, v58
  s_nop 1
  v_permlane16_swap_b32 v58, v59
  v_max_f32 v58, v58, v59
  v_mov_b32 v59, v58
  s_nop 1
  v_permlane32_swap_b32 v58, v59
  v_max_f32 v58, v58, v59
  v_mul_f32 v58, 0xbfb8aa3b, v58
  s_mov_b32 s6, 0x3fb8aa3b
  v_fma_f32 v60, v112, s6, v58
  v_fma_f32 v61, v114, s6, v58
  v_fma_f32 v62, v116, s6, v58
  v_fma_f32 v63, v118, s6, v58
  v_exp_f32 v60, v60
  v_exp_f32 v61, v61
  v_exp_f32 v62, v62
  v_exp_f32 v63, v63
  v_cvt_pk_bf16_f32 v60, v60, v60
  v_cvt_pk_bf16_f32 v61, v61, v61
  v_cvt_pk_bf16_f32 v62, v62, v62
  v_cvt_pk_bf16_f32 v63, v63, v63
  v_mov_b32_dpp v56, v60 quad_perm:[0,0,2,2] row_mask:0xf bank_mask:0xf
  v_mov_b32_dpp v57, v61 quad_perm:[0,0,2,2] row_mask:0xf bank_mask:0xf
  v_mov_b32_dpp v58, v62 quad_perm:[0,0,2,2] row_mask:0xf bank_mask:0xf
  v_mov_b32_dpp v59, v63 quad_perm:[0,0,2,2] row_mask:0xf bank_mask:0xf
  v_and_b32 v48, v56, v3
  v_and_b32 v49, v56, v4
  v_and_b32 v50, v56, v5
  v_and_b32 v51, v56, v6
  s_nop 1
  v_mfma_f32_16x16x32_bf16 v[44:47], v[48:51], v[96:99], 0
  v_and_b32 v52, v57, v3
  v_and_b32 v53, v57, v4
  v_and_b32 v54, v57, v5
  v_and_b32 v55, v57, v6
  s_nop 1
  v_mfma_f32_16x16x32_bf16 v[44:47], v[52:55], v[100:103], v[44:47]
  v_and_b32 v48, v58, v3
  v_and_b32 v49, v58, v4
  v_and_b32 v50, v58, v5
  v_and_b32 v51, v58, v6
  s_nop 1
  v_mfma_f32_16x16x32_bf16 v[44:47], v[48:51], v[104:107], v[44:47]
  v_and_b32 v52, v59, v3
  v_and_b32 v53, v59, v4
  v_and_b32 v54, v59, v5
  v_and_b32 v55, v59, v6
  s_nop 1
  v_mfma_f32_16x16x32_bf16 v[44:47], v[52:55], v[108:111], v[44:47]
  v_and_b32 v60, s48, v60
  v_and_b32 v61, s48, v61
  v_and_b32 v62, s48, v62
  v_and_b32 v63, s48, v63
  v_mul_f32 v57, v60, v113
  v_fmac_f32 v57, v61, v115
  v_fmac_f32 v57, v62, v117
  v_fmac_f32 v57, v63, v119
  s_nop 1
  v_add_f32_dpp v57, v57, v57 quad_perm:[1,0,3,2] row_mask:0xf bank_mask:0xf
  s_nop 1
  v_add_f32_dpp v57, v57, v57 row_ror:8 row_mask:0xf bank_mask:0xf
  v_mov_b32 v59, v57
  s_nop 1
  v_permlane16_swap_b32 v57, v59
  v_add_f32 v57, v57, v59
  v_mov_b32 v59, v57
  s_nop 1
  v_permlane32_swap_b32 v57, v59
  v_add_f32 v57, v57, v59
  v_rcp_f32 v57, v57
  s_nop 0
  v_mul_f32 v44, v44, v57
  v_mul_f32 v45, v45, v57
  v_mul_f32 v46, v46, v57
  v_mul_f32 v47, v47, v57
  s_mov_b64 exec, s[52:53]
  ds_write_b128 v8, v[44:47] offset:4096
  s_waitcnt lgkmcnt(0)
  s_mov_b64 exec, 1
  ds_add_u32 v15, v162 offset:48
  s_mov_b64 exec, -1
L29:
  s_sub_u32 s49, s49, 1
  s_cbranch_scc1 TIMEOUT
  ds_read_b32 v14, v15 offset:48
  s_waitcnt lgkmcnt(0)
  v_cmp_gt_i32 vcc, 8, v14
  s_cbranch_vccnz L29
  ds_read_b128 v[96:99], v166 offset:0
  ds_read_b128 v[100:103], v166 offset:256
  ds_read_b128 v[104:107], v166 offset:2048
  ds_read_b128 v[108:111], v166 offset:2304
  s_waitcnt lgkmcnt(2)
  v_pk_add_f32 v[96:97], v[96:97], v[100:101]
  v_pk_add_f32 v[98:99], v[98:99], v[102:103]
  s_waitcnt lgkmcnt(0)
  v_pk_add_f32 v[104:105], v[104:105], v[108:109]
  v_pk_add_f32 v[106:107], v[106:107], v[110:111]
  v_pk_add_f32 v[96:97], v[96:97], v[104:105]
  v_pk_add_f32 v[98:99], v[98:99], v[106:107]
  v_cvt_pk_bf16_f32 v56, v96, v96
  v_cvt_pk_bf16_f32 v57, v97, v97
  v_cvt_pk_bf16_f32 v58, v98, v98
  v_cvt_pk_bf16_f32 v59, v99, v99
  v_and_b32 v48, v56, v3
  v_and_b32 v49, v56, v4
  v_and_b32 v50, v56, v5
  v_and_b32 v51, v56, v6
  s_nop 1
  v_mfma_f32_16x16x32_bf16 v[44:47], v[48:51], v[64:67], 0
  v_and_b32 v52, v57, v3
  v_and_b32 v53, v57, v4
  v_and_b32 v54, v57, v5
  v_and_b32 v55, v57, v6
  s_nop 1
  v_mfma_f32_16x16x32_bf16 v[44:47], v[52:55], v[68:71], v[44:47]
  v_and_b32 v48, v58, v3
  v_and_b32 v49, v58, v4
  v_and_b32 v50, v58, v5
  v_and_b32 v51, v58, v6
  s_nop 1
  v_mfma_f32_16x16x32_bf16 v[44:47], v[48:51], v[72:75], v[44:47]
  v_and_b32 v52, v59, v3
  v_and_b32 v53, v59, v4
  v_and_b32 v54, v59, v5
  v_and_b32 v55, v59, v6
  s_nop 1
  v_mfma_f32_16x16x32_bf16 v[44:47], v[52:55], v[76:79], v[44:47]
  s_waitcnt vmcnt(2)
  v_max3_u32 v165, v24, v25, v26
  v_max_u32 v165, v165, v27
  v_cmp_eq_u32 vcc, -1, v165
  s_cbranch_vccz GADONE
L31:
  buffer_load_dwordx4 v[24:27], v167, s[36:39], s66 offen offset:0 sc1
  s_waitcnt vmcnt(0)
  v_max3_u32 v165, v24, v25, v26
  v_max_u32 v165, v165, v27
  v_cmp_eq_u32 vcc, -1, v165
  s_cbranch_vccz L30
  s_mov_b64 exec, vcc
  s_sub_u32 s49, s49, 1
  s_cbranch_scc1 TIMEOUT
  s_sleep 1
  s_branch L31
L30:
  s_mov_b64 exec, -1
GADONE:
  v_mov_b32 v96, v24
  v_mov_b32 v97, v25
  v_mov_b32 v98, v26
  v_mov_b32 v99, v27
  v_permlane16_swap_b32 v24, v96
  v_permlane16_swap_b32 v25, v97
  v_permlane16_swap_b32 v26, v98
  v_permlane16_swap_b32 v27, v99
  v_add_f32 v24, v24, v96
  v_add_f32 v25, v25, v97
  v_add_f32 v26, v26, v98
  v_add_f32 v27, v27, v99
  v_mov_b32 v96, v24
  v_mov_b32 v97, v25
  v_mov_b32 v98, v26
  v_mov_b32 v99, v27
  v_permlane32_swap_b32 v24, v96
  v_permlane32_swap_b32 v25, v97
  v_permlane32_swap_b32 v26, v98
  v_permlane32_swap_b32 v27, v99
  v_add_f32 v24, v24, v96
  v_add_f32 v25, v25, v97
  v_add_f32 v26, v26, v98
  v_add_f32 v27, v27, v99
  v_cvt_pk_bf16_f32 v96, v24, v25
  v_cvt_pk_bf16_f32 v97, v26, v27
  v_lshlrev_b32 v24, 16, v96
  v_and_b32 v25, s48, v96
  v_lshlrev_b32 v26, 16, v97
  v_and_b32 v27, s48, v97
  s_mov_b64 exec, s[52:53]
  ds_write_b128 v8, v[44:47] offset:0
  s_waitcnt lgkmcnt(0)
  s_mov_b64 exec, 1
  ds_add_rtn_u32 v14, v15, v162 offset:32
  s_mov_b64 exec, -1
  s_waitcnt lgkmcnt(0)
  v_readfirstlane_b32 s50, v14
  s_cmp_lg_u32 s50, 7
  s_cbranch_scc1 P4DONE
  ds_read_b128 v[96:99], v10 offset:0
  ds_read_b128 v[100:103], v10 offset:256
  ds_read_b128 v[104:107], v10 offset:512
  ds_read_b128 v[108:111], v10 offset:768
  s_waitcnt lgkmcnt(0)
  v_pk_add_f32 v[96:97], v[96:97], v[100:101]
  v_pk_add_f32 v[98:99], v[98:99], v[102:103]
  v_pk_add_f32 v[104:105], v[104:105], v[108:109]
  v_pk_add_f32 v[106:107], v[106:107], v[110:111]
  v_pk_add_f32 v[44:45], v[96:97], v[104:105]
  v_pk_add_f32 v[46:47], v[98:99], v[106:107]
  v_mov_b32 v96, v44
  v_mov_b32 v97, v45
  v_mov_b32 v98, v46
  v_mov_b32 v99, v47
  v_permlane16_swap_b32 v44, v96
  v_permlane16_swap_b32 v45, v97
  v_permlane16_swap_b32 v46, v98
  v_permlane16_swap_b32 v47, v99
  v_add_f32 v44, v44, v96
  v_add_f32 v45, v45, v97
  v_add_f32 v46, v46, v98
  v_add_f32 v47, v47, v99
  v_mov_b32 v96, v44
  v_mov_b32 v97, v45
  v_mov_b32 v98, v46
  v_mov_b32 v99, v47
  v_permlane32_swap_b32 v44, v96
  v_permlane32_swap_b32 v45, v97
  v_permlane32_swap_b32 v46, v98
  v_permlane32_swap_b32 v47, v99
  v_add_f32 v44, v44, v96
  v_add_f32 v45, v45, v97
  v_add_f32 v46, v46, v98
  v_add_f32 v47, v47, v99
  v_pk_mul_f32 v[44:45], v[44:45], v[24:25]
  v_pk_mul_f32 v[46:47], v[46:47], v[26:27]
  v_lshrrev_b32 v12, 1, v163
  v_cvt_pk_bf16_f32 v44, v44, v45
  v_cvt_pk_bf16_f32 v45, v46, v47
  s_nop 0
  v_mov_b32_dpp v46, v44 quad_perm:[1,0,3,2] row_mask:0xf bank_mask:0xf
  v_mov_b32_dpp v47, v45 quad_perm:[1,0,3,2] row_mask:0xf bank_mask:0xf
  s_waitcnt vmcnt(0)
  s_mov_b64 exec, 0x5555
  buffer_store_dwordx4 v[44:47], v12, s[36:39], s64 offen sc1
  s_mov_b64 exec, -1
  s_branch P4DONE2
P4DONE:
  s_waitcnt vmcnt(0)
P4DONE2:
  s_cmp_ge_u32 s3, 224
  s_cbranch_scc1 P5DONE
  v_bfe_u32 v13, v1, 2, 1
  v_max3_u32 v165, v28, v29, v30
  v_max3_u32 v165, v165, v31, v32
  v_max3_u32 v165, v165, v33, v34
  v_max_u32 v165, v165, v35
  v_cmp_eq_u32 vcc, -1, v165
  s_cbranch_vccz SBDONE
L33:
  buffer_load_dwordx4 v[28:31], v36, s[36:39], s67 offen offset:0 sc1
  buffer_load_dwordx4 v[32:35], v36, s[36:39], s67 offen offset:128 sc1
  s_waitcnt vmcnt(0)
  v_max3_u32 v165, v28, v29, v30
  v_max3_u32 v165, v165, v31, v32
  v_max3_u32 v165, v165, v33, v34
  v_max_u32 v165, v165, v35
  v_cmp_eq_u32 vcc, -1, v165
  s_cbranch_vccz L32
  s_mov_b64 exec, vcc
  s_sub_u32 s49, s49, 1
  s_cbranch_scc1 TIMEOUT
  s_sleep 1
  s_branch L33
L32:
  s_mov_b64 exec, -1
SBDONE:
  v_and_b32 v155, s48, v157
  v_lshlrev_b32 v154, 16, v157
  v_and_b32 v153, s48, v156
  v_lshlrev_b32 v152, 16, v156
  v_add_f32_dpp v28, v28, v28 quad_perm:[1,0,3,2] row_mask:0xf bank_mask:0xf
  v_add_f32_dpp v29, v29, v29 quad_perm:[1,0,3,2] row_mask:0xf bank_mask:0xf
  v_add_f32_dpp v30, v30, v30 quad_perm:[1,0,3,2] row_mask:0xf bank_mask:0xf
  v_add_f32_dpp v31, v31, v31 quad_perm:[1,0,3,2] row_mask:0xf bank_mask:0xf
  v_add_f32_dpp v32, v32, v32 quad_perm:[1,0,3,2] row_mask:0xf bank_mask:0xf
  v_add_f32_dpp v33, v33, v33 quad_perm:[1,0,3,2] row_mask:0xf bank_mask:0xf
  v_add_f32_dpp v34, v34, v34 quad_perm:[1,0,3,2] row_mask:0xf bank_mask:0xf
  v_add_f32_dpp v35, v35, v35 quad_perm:[1,0,3,2] row_mask:0xf bank_mask:0xf
  v_add_f32_dpp v28, v28, v28 quad_perm:[2,3,0,1] row_mask:0xf bank_mask:0xf
  v_add_f32_dpp v29, v29, v29 quad_perm:[2,3,0,1] row_mask:0xf bank_mask:0xf
  v_add_f32_dpp v30, v30, v30 quad_perm:[2,3,0,1] row_mask:0xf bank_mask:0xf
  v_add_f32_dpp v31, v31, v31 quad_perm:[2,3,0,1] row_mask:0xf bank_mask:0xf
  v_add_f32_dpp v32, v32, v32 quad_perm:[2,3,0,1] row_mask:0xf bank_mask:0xf
  v_add_f32_dpp v33, v33, v33 quad_perm:[2,3,0,1] row_mask:0xf bank_mask:0xf
  v_add_f32_dpp v34, v34, v34 quad_perm:[2,3,0,1] row_mask:0xf bank_mask:0xf
  v_add_f32_dpp v35, v35, v35 quad_perm:[2,3,0,1] row_mask:0xf bank_mask:0xf
  v_cvt_pk_bf16_f32 v56, v28, v29
  v_cvt_pk_bf16_f32 v57, v30, v31
  v_cvt_pk_bf16_f32 v58, v32, v33
  v_cvt_pk_bf16_f32 v59, v34, v35
  v_lshlrev_b32 v28, 16, v56
  v_and_b32 v29, s48, v56
  v_lshlrev_b32 v30, 16, v57
  v_and_b32 v31, s48, v57
  v_lshlrev_b32 v32, 16, v58
  v_and_b32 v33, s48, v58
  v_lshlrev_b32 v34, 16, v59
  v_and_b32 v35, s48, v59
  v_cmp_eq_u32 vcc, 1, v13
  v_mov_b32_dpp v96, v28 row_half_mirror row_mask:0xf bank_mask:0xf
  v_mov_b32_dpp v97, v29 row_half_mirror row_mask:0xf bank_mask:0xf
  v_mov_b32_dpp v98, v30 row_half_mirror row_mask:0xf bank_mask:0xf
  v_mov_b32_dpp v99, v31 row_half_mirror row_mask:0xf bank_mask:0xf
  v_mov_b32_dpp v100, v32 row_half_mirror row_mask:0xf bank_mask:0xf
  v_mov_b32_dpp v101, v33 row_half_mirror row_mask:0xf bank_mask:0xf
  v_mov_b32_dpp v102, v34 row_half_mirror row_mask:0xf bank_mask:0xf
  v_mov_b32_dpp v103, v35 row_half_mirror row_mask:0xf bank_mask:0xf
  v_cndmask_b32 v36, v28, v96, vcc
  v_cndmask_b32 v28, v96, v28, vcc
  v_cndmask_b32 v37, v29, v97, vcc
  v_cndmask_b32 v29, v97, v29, vcc
  v_cndmask_b32 v38, v30, v98, vcc
  v_cndmask_b32 v30, v98, v30, vcc
  v_cndmask_b32 v39, v31, v99, vcc
  v_cndmask_b32 v31, v99, v31, vcc
  v_cndmask_b32 v40, v32, v100, vcc
  v_cndmask_b32 v32, v100, v32, vcc
  v_cndmask_b32 v41, v33, v101, vcc
  v_cndmask_b32 v33, v101, v33, vcc
  v_cndmask_b32 v42, v34, v102, vcc
  v_cndmask_b32 v34, v102, v34, vcc
  v_cndmask_b32 v43, v35, v103, vcc
  v_cndmask_b32 v35, v103, v35, vcc
  v_add_f32 v28, 1.0, v28
  v_add_f32 v29, 1.0, v29
  v_add_f32 v30, 1.0, v30
  v_add_f32 v31, 1.0, v31
  v_add_f32 v32, 1.0, v32
  v_add_f32 v33, 1.0, v33
  v_add_f32 v34, 1.0, v34
  v_add_f32 v35, 1.0, v35
  v_cvt_pk_bf16_f32 v56, v28, v29
  v_cvt_pk_bf16_f32 v57, v30, v31
  v_cvt_pk_bf16_f32 v58, v32, v33
  v_cvt_pk_bf16_f32 v59, v34, v35
  v_lshlrev_b32 v28, 16, v56
  v_and_b32 v29, s48, v56
  v_lshlrev_b32 v30, 16, v57
  v_and_b32 v31, s48, v57
  v_lshlrev_b32 v32, 16, v58
  v_and_b32 v33, s48, v58
  v_lshlrev_b32 v34, 16, v59
  v_and_b32 v35, s48, v59
  s_lshl_b32 s6, s59, 1
  s_add_u32 s6, s6, s58
  s_mul_i32 s6, s6, 14336
  s_lshl_b32 s7, s60, 8
  s_add_u32 s6, s6, s7
  s_add_u32 s6, s6, 1478656
  s_mov_b32 s64, s6
  s_lshl_b32 s6, s4, 9
  s_add_u32 s6, s6, 155776
  v_lshl_add_u32 v166, v163, 1, s6
  v_lshl_add_u32 v166, v164, 4, v166
  s_add_u32 s6, s62, 155776
  v_lshl_add_u32 v13, v2, 4, s6
  v_lshlrev_b32 v12, 4, v1
  v_add_u32 v167, 155776, v12
  s_lshl_b32 s51, s4, 1
  s_add_u32 s51, s51, 34
  s_lshl_b32 s6, s4, 12
  v_add_u32 v16, s6, v11
  s_add_u32 s6, s6, 1413120
  ds_read_b32 v14, v15
  s_waitcnt lgkmcnt(0)
  v_cmp_gt_i32 vcc, s51, v14
  s_mov_b32 s65, 0
  s_cbranch_vccnz NOEARLY
  s_mov_b32 s65, 1
  ds_read_b128 v[64:67], v16 offset:0
  ds_read_b128 v[68:71], v16 offset:1024
  ds_read_b128 v[72:75], v16 offset:2048
  ds_read_b128 v[76:79], v16 offset:3072
  ds_read_b128 v[80:83], v16 offset:4096
  ds_read_b128 v[84:87], v16 offset:5120
  ds_read_b128 v[88:91], v16 offset:6144
  ds_read_b128 v[92:95], v16 offset:7168
NOEARLY:
  v_lshlrev_b32 v123, 7, v1
  s_cmp_lg_u32 s4, 0
  s_cbranch_scc1 L37
  s_mov_b64 exec, 0x1
L35:
  buffer_load_dwordx2 v[124:125], v123, s[36:39], s6 offen sc1
  s_waitcnt vmcnt(0)
  v_max_u32 v165, v124, v125
  v_cmp_eq_u32 vcc, -1, v165
  s_cbranch_vccz L36
  s_sub_u32 s49, s49, 1
  s_cbranch_scc1 TIMEOUT
  s_sleep 1
  s_branch L35
L36:
  s_waitcnt lgkmcnt(0)
  s_mov_b64 exec, 1
  ds_add_u32 v15, v162 offset:76
  s_mov_b64 exec, -1
  s_branch L38
L37:
L39:
  s_sub_u32 s49, s49, 1
  s_cbranch_scc1 TIMEOUT
  s_sleep 1
  ds_read_b32 v14, v15 offset:76
  s_waitcnt lgkmcnt(0)
  v_cmp_gt_i32 vcc, 1, v14
  s_cbranch_vccnz L39
L38:
  s_mov_b64 exec, -1
  buffer_load_dwordx4 v[96:99], v12, s[36:39], s6 offen offset:0
  buffer_load_dwordx4 v[100:103], v12, s[36:39], s6 offen offset:1024
  buffer_load_dwordx4 v[104:107], v12, s[36:39], s6 offen offset:2048
  buffer_load_dwordx4 v[108:111], v12, s[36:39], s6 offen offset:3072
  s_waitcnt vmcnt(0)
  v_max3_u32 v165, v96, v97, v98
  v_max3_u32 v165, v165, v99, v100
  v_max3_u32 v165, v165, v101, v102
  v_max3_u32 v165, v165, v103, v104
  v_max3_u32 v165, v165, v105, v106
  v_max3_u32 v165, v165, v107, v108
  v_max3_u32 v165, v165, v109, v110
  v_max_u32 v165, v165, v111
  v_cmp_eq_u32 vcc, -1, v165
  s_cbranch_vccz L34
  s_mov_b64 exec, vcc
L40:
  buffer_load_dwordx4 v[96:99], v12, s[36:39], s6 offen offset:0 sc1
  buffer_load_dwordx4 v[100:103], v12, s[36:39], s6 offen offset:1024 sc1
  buffer_load_dwordx4 v[104:107], v12, s[36:39], s6 offen offset:2048 sc1
  buffer_load_dwordx4 v[108:111], v12, s[36:39], s6 offen offset:3072 sc1
  s_waitcnt vmcnt(0)
  v_max3_u32 v165, v96, v97, v98
  v_max3_u32 v165, v165, v99, v100
  v_max3_u32 v165, v165, v101, v102
  v_max3_u32 v165, v165, v103, v104
  v_max3_u32 v165, v165, v105, v106
  v_max3_u32 v165, v165, v107, v108
  v_max3_u32 v165, v165, v109, v110
  v_max_u32 v165, v165, v111
  v_cmp_eq_u32 vcc, -1, v165
  s_cbranch_vccz L34
  s_mov_b64 exec, vcc
  s_sub_u32 s49, s49, 1
  s_cbranch_scc1 TIMEOUT
  s_sleep 1
  s_branch L40
L34:
  s_mov_b64 exec, -1
  s_waitcnt lgkmcnt(0)
  s_mov_b64 exec, 1
  ds_add_u32 v15, v162 offset:88
  s_mov_b64 exec, -1
  v_mfma_f32_16x16x32_bf16 v[44:47], v[158:161], v[96:99], v[152:155]
  v_mfma_f32_16x16x32_bf16 v[44:47], v[158:161], v[100:103], v[44:47]
  v_mfma_f32_16x16x32_bf16 v[44:47], v[158:161], v[104:107], v[44:47]
  v_mfma_f32_16x16x32_bf16 v[44:47], v[158:161], v[108:111], v[44:47]
  s_mov_b32 exec_hi, 0
  s_nop 6
  ds_write_b128 v166, v[44:47]
  s_waitcnt lgkmcnt(0)
  s_mov_b64 exec, 1
  ds_add_u32 v15, v162 offset:36
  s_mov_b64 exec, -1
L41:
  s_sub_u32 s49, s49, 1
  s_cbranch_scc1 TIMEOUT
  ds_read_b32 v14, v15 offset:36
  s_waitcnt lgkmcnt(0)
  v_cmp_gt_i32 vcc, 8, v14
  s_cbranch_vccnz L41
  ds_read_b32 v60, v15 offset:8320
  ds_read_b128 v[96:99], v167 offset:0
  ds_read_b128 v[100:103], v167 offset:1024
  ds_read_b128 v[104:107], v167 offset:2048
  ds_read_b128 v[108:111], v167 offset:3072
  ds_read_b128 v[112:115], v13
  ds_read_b128 v[116:119], v13 offset:128
  s_waitcnt lgkmcnt(5)
  v_pk_add_f32 v[96:97], v[96:97], v[60:61] op_sel_hi:[1,0] neg_lo:[0,1] neg_hi:[0,1]
  v_pk_add_f32 v[98:99], v[98:99], v[60:61] op_sel_hi:[1,0] neg_lo:[0,1] neg_hi:[0,1]
  s_waitcnt lgkmcnt(4)
  v_pk_add_f32 v[100:101], v[100:101], v[60:61] op_sel_hi:[1,0] neg_lo:[0,1] neg_hi:[0,1]
  v_pk_add_f32 v[102:103], v[102:103], v[60:61] op_sel_hi:[1,0] neg_lo:[0,1] neg_hi:[0,1]
  s_waitcnt lgkmcnt(3)
  v_pk_add_f32 v[104:105], v[104:105], v[60:61] op_sel_hi:[1,0] neg_lo:[0,1] neg_hi:[0,1]
  v_pk_add_f32 v[106:107], v[106:107], v[60:61] op_sel_hi:[1,0] neg_lo:[0,1] neg_hi:[0,1]
  s_waitcnt lgkmcnt(2)
  v_pk_add_f32 v[108:109], v[108:109], v[60:61] op_sel_hi:[1,0] neg_lo:[0,1] neg_hi:[0,1]
  v_pk_add_f32 v[110:111], v[110:111], v[60:61] op_sel_hi:[1,0] neg_lo:[0,1] neg_hi:[0,1]
  v_pk_add_f32 v[56:57], v[96:97], v[98:99]
  v_pk_mul_f32 v[58:59], v[96:97], v[96:97]
  v_pk_fma_f32 v[58:59], v[98:99], v[98:99], v[58:59]
  v_pk_add_f32 v[56:57], v[56:57], v[100:101]
  v_pk_fma_f32 v[58:59], v[100:101], v[100:101], v[58:59]
  v_pk_add_f32 v[56:57], v[56:57], v[102:103]
  v_pk_fma_f32 v[58:59], v[102:103], v[102:103], v[58:59]
  v_pk_add_f32 v[56:57], v[56:57], v[104:105]
  v_pk_fma_f32 v[58:59], v[104:105], v[104:105], v[58:59]
  v_pk_add_f32 v[56:57], v[56:57], v[106:107]
  v_pk_fma_f32 v[58:59], v[106:107], v[106:107], v[58:59]
  v_pk_add_f32 v[56:57], v[56:57], v[108:109]
  v_pk_fma_f32 v[58:59], v[108:109], v[108:109], v[58:59]
  v_pk_add_f32 v[56:57], v[56:57], v[110:111]
  v_pk_fma_f32 v[58:59], v[110:111], v[110:111], v[58:59]
  v_add_f32 v56, v56, v57
  v_add_f32 v57, v58, v59
  s_nop 0
  v_add_f32_dpp v56, v56, v56 quad_perm:[1,0,3,2] row_mask:0xf bank_mask:0xf
  v_add_f32_dpp v57, v57, v57 quad_perm:[1,0,3,2] row_mask:0xf bank_mask:0xf
  s_nop 0
  v_add_f32_dpp v56, v56, v56 quad_perm:[2,3,0,1] row_mask:0xf bank_mask:0xf
  v_add_f32_dpp v57, v57, v57 quad_perm:[2,3,0,1] row_mask:0xf bank_mask:0xf
  s_nop 0
  v_add_f32_dpp v56, v56, v56 row_half_mirror row_mask:0xf bank_mask:0xf
  v_add_f32_dpp v57, v57, v57 row_half_mirror row_mask:0xf bank_mask:0xf
  s_nop 0
  v_add_f32_dpp v56, v56, v56 row_mirror row_mask:0xf bank_mask:0xf
  v_add_f32_dpp v57, v57, v57 row_mirror row_mask:0xf bank_mask:0xf
  v_mov_b32 v58, v56
  v_mov_b32 v59, v57
  s_nop 0
  v_permlane16_swap_b32 v56, v58
  v_permlane16_swap_b32 v57, v59
  v_add_f32 v56, v56, v58
  v_add_f32 v57, v57, v59
  v_mov_b32 v58, v56
  v_mov_b32 v59, v57
  s_nop 0
  v_permlane32_swap_b32 v56, v58
  v_permlane32_swap_b32 v57, v59
  v_add_f32 v56, v56, v58
  v_add_f32 v57, v57, v59
  v_mul_f32 v56, 0x3a800000, v56
  v_mul_f32 v57, 0x3a800000, v57
  v_fma_f32 v57, -v56, v56, v57
  v_add_f32 v60, v60, v56
  v_add_f32 v57, 0x3727c5ac, v57
  v_rsq_f32 v58, v57
  s_waitcnt lgkmcnt(0)
  v_pk_add_f32 v[112:113], v[112:113], v[60:61] op_sel_hi:[1,0] neg_lo:[0,1] neg_hi:[0,1]
  v_pk_add_f32 v[114:115], v[114:115], v[60:61] op_sel_hi:[1,0] neg_lo:[0,1] neg_hi:[0,1]
  v_pk_add_f32 v[116:117], v[116:117], v[60:61] op_sel_hi:[1,0] neg_lo:[0,1] neg_hi:[0,1]
  v_pk_add_f32 v[118:119], v[118:119], v[60:61] op_sel_hi:[1,0] neg_lo:[0,1] neg_hi:[0,1]
  v_pk_mul_f32 v[28:29], v[28:29], v[58:59] op_sel_hi:[1,0]
  v_pk_mul_f32 v[30:31], v[30:31], v[58:59] op_sel_hi:[1,0]
  v_pk_mul_f32 v[32:33], v[32:33], v[58:59] op_sel_hi:[1,0]
  v_pk_mul_f32 v[34:35], v[34:35], v[58:59] op_sel_hi:[1,0]
  v_pk_fma_f32 v[112:113], v[112:113], v[28:29], v[36:37]
  v_pk_fma_f32 v[114:115], v[114:115], v[30:31], v[38:39]
  v_pk_fma_f32 v[116:117], v[116:117], v[32:33], v[40:41]
  v_pk_fma_f32 v[118:119], v[118:119], v[34:35], v[42:43]
  v_cvt_pk_bf16_f32 v56, v112, v112
  v_cvt_pk_bf16_f32 v57, v113, v113
  v_cvt_pk_bf16_f32 v58, v114, v114
  v_cvt_pk_bf16_f32 v59, v115, v115
  v_cvt_pk_bf16_f32 v60, v116, v116
  v_cvt_pk_bf16_f32 v61, v117, v117
  v_cvt_pk_bf16_f32 v62, v118, v118
  v_cvt_pk_bf16_f32 v63, v119, v119
  s_cmp_eq_u32 s65, 1
  s_cbranch_scc1 EARLY
L42:
  s_sub_u32 s49, s49, 1
  s_cbranch_scc1 TIMEOUT
  ds_read_b32 v14, v15 offset:0
  s_waitcnt lgkmcnt(0)
  v_cmp_gt_i32 vcc, s51, v14
  s_cbranch_vccnz L42
  ds_read_b128 v[64:67], v16 offset:0
  ds_read_b128 v[68:71], v16 offset:1024
  ds_read_b128 v[72:75], v16 offset:2048
  ds_read_b128 v[76:79], v16 offset:3072
  ds_read_b128 v[80:83], v16 offset:4096
  ds_read_b128 v[84:87], v16 offset:5120
  ds_read_b128 v[88:91], v16 offset:6144
  ds_read_b128 v[92:95], v16 offset:7168
  s_waitcnt lgkmcnt(0)
EARLY:
  v_and_b32 v48, v56, v3
  v_and_b32 v49, v56, v4
  v_and_b32 v50, v56, v5
  v_and_b32 v51, v56, v6
  s_nop 1
  v_mfma_f32_16x16x32_bf16 v[44:47], v[48:51], v[64:67], 0
  v_and_b32 v52, v57, v3
  v_and_b32 v53, v57, v4
  v_and_b32 v54, v57, v5
  v_and_b32 v55, v57, v6
  s_nop 1
  v_mfma_f32_16x16x32_bf16 v[44:47], v[52:55], v[68:71], v[44:47]
  v_and_b32 v48, v58, v3
  v_and_b32 v49, v58, v4
  v_and_b32 v50, v58, v5
  v_and_b32 v51, v58, v6
  s_nop 1
  v_mfma_f32_16x16x32_bf16 v[44:47], v[48:51], v[72:75], v[44:47]
  v_and_b32 v52, v59, v3
  v_and_b32 v53, v59, v4
  v_and_b32 v54, v59, v5
  v_and_b32 v55, v59, v6
  s_nop 1
  v_mfma_f32_16x16x32_bf16 v[44:47], v[52:55], v[76:79], v[44:47]
  v_and_b32 v48, v60, v3
  v_and_b32 v49, v60, v4
  v_and_b32 v50, v60, v5
  v_and_b32 v51, v60, v6
  s_nop 1
  v_mfma_f32_16x16x32_bf16 v[44:47], v[48:51], v[80:83], v[44:47]
  v_and_b32 v52, v61, v3
  v_and_b32 v53, v61, v4
  v_and_b32 v54, v61, v5
  v_and_b32 v55, v61, v6
  s_nop 1
  v_mfma_f32_16x16x32_bf16 v[44:47], v[52:55], v[84:87], v[44:47]
  v_and_b32 v48, v62, v3
  v_and_b32 v49, v62, v4
  v_and_b32 v50, v62, v5
  v_and_b32 v51, v62, v6
  s_nop 1
  v_mfma_f32_16x16x32_bf16 v[44:47], v[48:51], v[88:91], v[44:47]
  v_and_b32 v52, v63, v3
  v_and_b32 v53, v63, v4
  v_and_b32 v54, v63, v5
  v_and_b32 v55, v63, v6
  s_nop 1
  v_mfma_f32_16x16x32_bf16 v[44:47], v[52:55], v[92:95], v[44:47]
  s_mov_b64 exec, s[52:53]
  s_nop 6
  ds_write_b128 v8, v[44:47] offset:0
  s_waitcnt lgkmcnt(0)
  s_mov_b64 exec, 1
  ds_add_rtn_u32 v14, v15, v162 offset:40
  s_mov_b64 exec, -1
  s_waitcnt lgkmcnt(0)
  v_readfirstlane_b32 s50, v14
  s_cmp_lg_u32 s50, 7
  s_cbranch_scc1 P5DONE
  ds_read_b128 v[96:99], v10 offset:0
  ds_read_b128 v[100:103], v10 offset:256
  ds_read_b128 v[104:107], v10 offset:512
  ds_read_b128 v[108:111], v10 offset:768
  s_waitcnt lgkmcnt(0)
  v_pk_add_f32 v[96:97], v[96:97], v[100:101]
  v_pk_add_f32 v[98:99], v[98:99], v[102:103]
  v_pk_add_f32 v[104:105], v[104:105], v[108:109]
  v_pk_add_f32 v[106:107], v[106:107], v[110:111]
  v_pk_add_f32 v[44:45], v[96:97], v[104:105]
  v_pk_add_f32 v[46:47], v[98:99], v[106:107]
  v_mov_b32 v96, v44
  v_mov_b32 v97, v45
  v_mov_b32 v98, v46
  v_mov_b32 v99, v47
  v_permlane16_swap_b32 v44, v96
  v_permlane16_swap_b32 v45, v97
  v_permlane16_swap_b32 v46, v98
  v_permlane16_swap_b32 v47, v99
  v_add_f32 v44, v44, v96
  v_add_f32 v45, v45, v97
  v_add_f32 v46, v46, v98
  v_add_f32 v47, v47, v99
  v_mov_b32 v96, v44
  v_mov_b32 v97, v45
  v_mov_b32 v98, v46
  v_mov_b32 v99, v47
  v_permlane32_swap_b32 v44, v96
  v_permlane32_swap_b32 v45, v97
  v_permlane32_swap_b32 v46, v98
  v_permlane32_swap_b32 v47, v99
  v_add_f32 v44, v44, v96
  v_add_f32 v45, v45, v97
  v_add_f32 v46, v46, v98
  v_add_f32 v47, v47, v99
  s_mov_b64 exec, 0xffff
  buffer_store_dwordx4 v[44:47], v163, s[36:39], s64 offen sc1
  s_mov_b64 exec, -1
P5DONE:
  v_subrev_u32 v8, 82048, v8
  v_subrev_u32 v10, 82048, v10
  v_mov_b32 v44, 0
  v_mov_b32 v45, 0
  v_mov_b32 v46, 0
  v_mov_b32 v47, 0
  s_cmp_eq_u32 s4, 7
  s_cbranch_scc1 P6RED
  s_add_u32 s50, s4, 49
L43:
  s_sub_u32 s49, s49, 1
  s_cbranch_scc1 TIMEOUT
  ds_read_b32 v14, v15 offset:0
  s_waitcnt lgkmcnt(0)
  v_cmp_gt_i32 vcc, s50, v14
  s_cbranch_vccnz L43
  v_add_u32 v12, 81920, v11
  ds_read_b128 v[64:67], v12 offset:0
  ds_read_b128 v[68:71], v12 offset:1024
  ds_read_b128 v[72:75], v12 offset:2048
  ds_read_b128 v[76:79], v12 offset:3072
  s_mul_i32 s6, s57, 896
  s_lshl_b32 s7, s4, 7
  s_add_u32 s6, s6, s7
  s_add_u32 s6, s6, 1478656
  v_and_b32 v13, 3, v2
  v_mul_u32_u24 v12, 14336, v13
  v_add_u32 v12, v12, v9
  v_lshlrev_b32 v13, 2, v2
  s_mov_b32 exec_hi, 0
L45:
  buffer_load_dwordx4 v[96:99], v12, s[36:39], s6 offen offset:0 sc1
  s_waitcnt vmcnt(0)
  v_max3_u32 v165, v96, v97, v98
  v_max_u32 v165, v165, v99
  v_cmp_eq_u32 vcc, -1, v165
  s_cbranch_vccz L44
  s_mov_b64 exec, vcc
  s_sub_u32 s49, s49, 1
  s_cbranch_scc1 TIMEOUT
  s_sleep 1
  s_branch L45
L44:
  s_mov_b64 exec, -1
  s_mov_b64 exec, -1
  v_add_f32_dpp v104, v96, v96 row_ror:8 row_mask:0xf bank_mask:0xf
  v_add_f32_dpp v105, v97, v97 row_ror:8 row_mask:0xf bank_mask:0xf
  v_add_f32_dpp v106, v98, v98 row_ror:8 row_mask:0xf bank_mask:0xf
  v_add_f32_dpp v107, v99, v99 row_ror:8 row_mask:0xf bank_mask:0xf
  v_mov_b32 v108, v104
  v_mov_b32 v109, v105
  v_mov_b32 v110, v106
  v_mov_b32 v111, v107
  v_permlane16_swap_b32 v104, v108
  v_permlane16_swap_b32 v105, v109
  v_permlane16_swap_b32 v106, v110
  v_permlane16_swap_b32 v107, v111
  s_mov_b32 s6, 0xbdd2d3e8
  v_mov_b32 v100, 0xc0135761
  v_mul_f32 v96, v104, v104
  v_mul_f32 v97, v105, v105
  v_mul_f32 v98, v106, v106
  v_mul_f32 v99, v107, v107
  v_fma_f32 v96, v96, s6, v100
  v_fma_f32 v97, v97, s6, v100
  v_fma_f32 v98, v98, s6, v100
  v_fma_f32 v99, v99, s6, v100
  v_mul_f32 v96, v96, v104
  v_mul_f32 v97, v97, v105
  v_mul_f32 v98, v98, v106
  v_mul_f32 v99, v99, v107
  v_exp_f32 v96, v96
  v_exp_f32 v97, v97
  v_exp_f32 v98, v98
  v_exp_f32 v99, v99
  v_add_f32 v96, 1.0, v96
  v_add_f32 v97, 1.0, v97
  v_add_f32 v98, 1.0, v98
  v_add_f32 v99, 1.0, v99
  v_rcp_f32 v96, v96
  v_rcp_f32 v97, v97
  v_rcp_f32 v98, v98
  v_rcp_f32 v99, v99
  v_mul_f32 v104, v104, v96
  v_mul_f32 v105, v105, v97
  v_mul_f32 v106, v106, v98
  v_mul_f32 v107, v107, v99
  v_mul_f32 v104, v104, v108
  v_mul_f32 v105, v105, v109
  v_mul_f32 v106, v106, v110
  v_mul_f32 v107, v107, v111
  v_cvt_pk_bf16_f32 v60, v104, v104
  v_cvt_pk_bf16_f32 v61, v105, v105
  v_cvt_pk_bf16_f32 v62, v106, v106
  v_cvt_pk_bf16_f32 v63, v107, v107
  ds_bpermute_b32 v56, v13, v60
  ds_bpermute_b32 v57, v13, v61
  ds_bpermute_b32 v58, v13, v62
  ds_bpermute_b32 v59, v13, v63
  s_waitcnt lgkmcnt(0)
  v_and_b32 v48, v56, v3
  v_and_b32 v49, v56, v4
  v_and_b32 v50, v56, v5
  v_and_b32 v51, v56, v6
  s_nop 1
  v_mfma_f32_16x16x32_bf16 v[44:47], v[48:51], v[64:67], 0
  v_and_b32 v52, v57, v3
  v_and_b32 v53, v57, v4
  v_and_b32 v54, v57, v5
  v_and_b32 v55, v57, v6
  s_nop 1
  v_mfma_f32_16x16x32_bf16 v[44:47], v[52:55], v[68:71], v[44:47]
  v_and_b32 v48, v58, v3
  v_and_b32 v49, v58, v4
  v_and_b32 v50, v58, v5
  v_and_b32 v51, v58, v6
  s_nop 1
  v_mfma_f32_16x16x32_bf16 v[44:47], v[48:51], v[72:75], v[44:47]
  v_and_b32 v52, v59, v3
  v_and_b32 v53, v59, v4
  v_and_b32 v54, v59, v5
  v_and_b32 v55, v59, v6
  s_nop 1
  v_mfma_f32_16x16x32_bf16 v[44:47], v[52:55], v[76:79], v[44:47]
P6RED:
  s_mov_b64 exec, s[52:53]
  s_nop 6
  ds_write_b128 v8, v[44:47] offset:0
  s_waitcnt lgkmcnt(0)
  s_mov_b64 exec, 1
  ds_add_rtn_u32 v14, v15, v162 offset:44
  s_mov_b64 exec, -1
  s_waitcnt lgkmcnt(0)
  v_readfirstlane_b32 s50, v14
  s_cmp_lg_u32 s50, 7
  s_cbranch_scc1 P6DONE
  ds_read_b128 v[96:99], v10 offset:0
  ds_read_b128 v[100:103], v10 offset:256
  ds_read_b128 v[104:107], v10 offset:512
  ds_read_b128 v[108:111], v10 offset:768
  s_waitcnt lgkmcnt(0)
  v_pk_add_f32 v[96:97], v[96:97], v[100:101]
  v_pk_add_f32 v[98:99], v[98:99], v[102:103]
  v_pk_add_f32 v[104:105], v[104:105], v[108:109]
  v_pk_add_f32 v[106:107], v[106:107], v[110:111]
  v_pk_add_f32 v[44:45], v[96:97], v[104:105]
  v_pk_add_f32 v[46:47], v[98:99], v[106:107]
  v_mov_b32 v96, v44
  v_mov_b32 v97, v45
  v_mov_b32 v98, v46
  v_mov_b32 v99, v47
  v_permlane16_swap_b32 v44, v96
  v_permlane16_swap_b32 v45, v97
  v_permlane16_swap_b32 v46, v98
  v_permlane16_swap_b32 v47, v99
  v_add_f32 v44, v44, v96
  v_add_f32 v45, v45, v97
  v_add_f32 v46, v46, v98
  v_add_f32 v47, v47, v99
  v_mov_b32 v96, v44
  v_mov_b32 v97, v45
  v_mov_b32 v98, v46
  v_mov_b32 v99, v47
  v_permlane32_swap_b32 v44, v96
  v_permlane32_swap_b32 v45, v97
  v_permlane32_swap_b32 v46, v98
  v_permlane32_swap_b32 v47, v99
  v_add_f32 v44, v44, v96
  v_add_f32 v45, v45, v97
  v_add_f32 v46, v46, v98
  v_add_f32 v47, v47, v99
  s_lshl_b32 s6, s57, 12
  s_lshl_b32 s7, s56, 8
  s_add_u32 s6, s6, s7
  s_add_u32 s6, s6, 1536000
  s_mov_b64 exec, 0xffff
  buffer_store_dwordx4 v[44:47], v163, s[36:39], s6 offen sc1
  s_mov_b64 exec, -1
P6DONE:
  s_cmp_lg_u32 s4, 7
  s_cbranch_scc1 TIMEOUT
  s_cmp_ge_u32 s3, 64
  s_cbranch_scc1 TIMEOUT
  s_lshl_b32 s62, s3, 6
  s_add_u32 s6, s62, 1359872
  v_and_b32 v12, 3, v1
  v_lshlrev_b32 v12, 14, v12
  v_lshl_add_u32 v12, v164, 4, v12
  s_add_u32 s7, s62, 155776
  v_lshl_add_u32 v13, v164, 4, s7
  ds_read_b128 v[28:31], v13
  buffer_load_dwordx4 v[24:27], v12, s[36:39], s6 offen offset:0
  s_waitcnt vmcnt(0)
  v_max3_u32 v165, v24, v25, v26
  v_max_u32 v165, v165, v27
  v_cmp_eq_u32 vcc, -1, v165
  s_cbranch_vccz L46
  s_mov_b64 exec, vcc
L47:
  buffer_load_dwordx4 v[24:27], v12, s[36:39], s6 offen offset:0 sc1
  s_waitcnt vmcnt(0)
  v_max3_u32 v165, v24, v25, v26
  v_max_u32 v165, v165, v27
  v_cmp_eq_u32 vcc, -1, v165
  s_cbranch_vccz L46
  s_mov_b64 exec, vcc
  s_sub_u32 s49, s49, 1
  s_cbranch_scc1 TIMEOUT
  s_sleep 1
  s_branch L47
L46:
  s_mov_b64 exec, -1
  v_add_f32_dpp v24, v24, v24 quad_perm:[1,0,3,2] row_mask:0xf bank_mask:0xf
  v_add_f32_dpp v25, v25, v25 quad_perm:[1,0,3,2] row_mask:0xf bank_mask:0xf
  v_add_f32_dpp v26, v26, v26 quad_perm:[1,0,3,2] row_mask:0xf bank_mask:0xf
  v_add_f32_dpp v27, v27, v27 quad_perm:[1,0,3,2] row_mask:0xf bank_mask:0xf
  v_add_f32_dpp v24, v24, v24 quad_perm:[2,3,0,1] row_mask:0xf bank_mask:0xf
  v_add_f32_dpp v25, v25, v25 quad_perm:[2,3,0,1] row_mask:0xf bank_mask:0xf
  v_add_f32_dpp v26, v26, v26 quad_perm:[2,3,0,1] row_mask:0xf bank_mask:0xf
  v_add_f32_dpp v27, v27, v27 quad_perm:[2,3,0,1] row_mask:0xf bank_mask:0xf
  v_cvt_pk_bf16_f32 v56, v24, v25
  v_cvt_pk_bf16_f32 v57, v26, v27
  v_lshlrev_b32 v24, 16, v56
  v_and_b32 v25, s48, v56
  v_lshlrev_b32 v26, 16, v57
  v_and_b32 v27, s48, v57
  s_add_u32 s6, s62, 1536000
  v_lshlrev_b32 v12, 8, v163
  v_lshl_add_u32 v12, v164, 4, v12
  s_mov_b32 s40, s30
  s_mov_b32 s41, s31
  s_mov_b32 s42, 2048
  s_mov_b32 s43, 0x20000
  s_waitcnt lgkmcnt(0)
L49:
  buffer_load_dwordx4 v[96:99], v12, s[36:39], s6 offen offset:0 sc1
  s_waitcnt vmcnt(0)
  v_max3_u32 v165, v96, v97, v98
  v_max_u32 v165, v165, v99
  v_cmp_eq_u32 vcc, -1, v165
  s_cbranch_vccz L48
  s_mov_b64 exec, vcc
  s_sub_u32 s49, s49, 1
  s_cbranch_scc1 TIMEOUT
  s_sleep 1
  s_branch L49
L48:
  s_mov_b64 exec, -1
  v_add_f32_dpp v96, v96, v96 quad_perm:[1,0,3,2] row_mask:0xf bank_mask:0xf
  v_add_f32_dpp v97, v97, v97 quad_perm:[1,0,3,2] row_mask:0xf bank_mask:0xf
  v_add_f32_dpp v98, v98, v98 quad_perm:[1,0,3,2] row_mask:0xf bank_mask:0xf
  v_add_f32_dpp v99, v99, v99 quad_perm:[1,0,3,2] row_mask:0xf bank_mask:0xf
  v_add_f32_dpp v96, v96, v96 quad_perm:[2,3,0,1] row_mask:0xf bank_mask:0xf
  v_add_f32_dpp v97, v97, v97 quad_perm:[2,3,0,1] row_mask:0xf bank_mask:0xf
  v_add_f32_dpp v98, v98, v98 quad_perm:[2,3,0,1] row_mask:0xf bank_mask:0xf
  v_add_f32_dpp v99, v99, v99 quad_perm:[2,3,0,1] row_mask:0xf bank_mask:0xf
  v_add_f32_dpp v96, v96, v96 row_half_mirror row_mask:0xf bank_mask:0xf
  v_add_f32_dpp v97, v97, v97 row_half_mirror row_mask:0xf bank_mask:0xf
  v_add_f32_dpp v98, v98, v98 row_half_mirror row_mask:0xf bank_mask:0xf
  v_add_f32_dpp v99, v99, v99 row_half_mirror row_mask:0xf bank_mask:0xf
  v_add_f32_dpp v96, v96, v96 row_mirror row_mask:0xf bank_mask:0xf
  v_add_f32_dpp v97, v97, v97 row_mirror row_mask:0xf bank_mask:0xf
  v_add_f32_dpp v98, v98, v98 row_mirror row_mask:0xf bank_mask:0xf
  v_add_f32_dpp v99, v99, v99 row_mirror row_mask:0xf bank_mask:0xf
  v_fma_f32 v96, v96, v24, v28
  v_fma_f32 v97, v97, v25, v29
  v_fma_f32 v98, v98, v26, v30
  v_fma_f32 v99, v99, v27, v31
  v_cvt_pk_bf16_f32 v96, v96, v97
  v_cvt_pk_bf16_f32 v97, v98, v99
  v_lshlrev_b32 v12, 3, v164
  s_lshl_b32 s6, s3, 5
  s_mov_b32 exec_lo, 0x10001
  s_mov_b32 exec_hi, 0x10001
  buffer_store_dwordx2 v[96:97], v12, s[40:43], s6 offen
  s_cmp_lg_u32 s3, 0
  s_cbranch_scc1 TIMEOUT
  s_mov_b64 exec, 1
  v_mov_b32 v12, 0
  v_mov_b32 v13, s5
  buffer_store_dword v13, v12, s[36:39], 0 offen sc1
TIMEOUT:
EXIT:
  s_endpgm
CLEAR:
  s_mov_b32 s36, s34
  s_mov_b32 s37, s35
  s_mov_b32 s38, 1601536
  s_mov_b32 s39, 0x20000
  v_and_b32 v163, 15, v1
  v_lshlrev_b32 v163, 4, v163
  v_mov_b32 v44, -1
  v_mov_b32 v45, -1
  v_mov_b32 v46, -1
  v_mov_b32 v47, -1
  s_cmp_eq_u32 s4, 4
  s_cbranch_scc0 CLR5
  s_lshl_b32 s6, s55, 17
  s_lshl_b32 s7, s54, 7
  s_add_u32 s6, s6, s7
  s_add_u32 s6, s6, 266240
  s_add_u32 s7, s6, 65536
  v_lshl_add_u32 v12, v2, 13, v9
  buffer_store_dwordx4 v[44:47], v12, s[36:39], s6 offen sc1
  buffer_store_dwordx4 v[44:47], v12, s[36:39], s7 offen sc1
  s_branch CLRD
CLR5:
  s_cmp_eq_u32 s4, 5
  s_cbranch_scc0 CLR6
  s_lshl_b32 s6, s55, 12
  s_lshl_b32 s7, s54, 3
  s_add_u32 s6, s6, s7
  s_add_u32 s6, s6, 1314816
  v_lshlrev_b32 v12, 9, v1
  s_mov_b64 exec, 0xff
  buffer_store_dwordx2 v[44:45], v12, s[36:39], s6 offen sc1
  s_mov_b64 exec, -1
  s_lshl_b32 s6, s55, 14
  s_lshl_b32 s7, s54, 8
  s_add_u32 s6, s6, s7
  s_add_u32 s6, s6, 1347584
  s_mov_b64 exec, 0xffff
  buffer_store_dwordx4 v[44:47], v163, s[36:39], s6 offen sc1
  s_mov_b64 exec, -1
  s_branch CLRD
CLR6:
  s_cmp_eq_u32 s4, 6
  s_cbranch_scc0 CLR7
  s_lshr_b32 s6, s56, 1
  s_lshl_b32 s6, s6, 12
  s_lshl_b32 s7, s57, 8
  s_add_u32 s6, s6, s7
  s_and_b32 s7, s56, 1
  s_lshl_b32 s7, s7, 7
  s_add_u32 s6, s6, s7
  s_add_u32 s64, s6, 1413120
  s_mov_b32 s6, s64
  s_mov_b64 exec, 0xff
  buffer_store_dwordx4 v[44:47], v163, s[36:39], s6 offen sc1
  s_mov_b64 exec, -1
  s_lshl_b32 s6, s57, 12
  s_lshl_b32 s7, s56, 8
  s_add_u32 s6, s6, s7
  s_add_u32 s6, s6, 1536000
  s_mov_b64 exec, 0xffff
  buffer_store_dwordx4 v[44:47], v163, s[36:39], s6 offen sc1
  s_mov_b64 exec, -1
  s_branch CLRD
CLR7:
  s_cmp_ge_u32 s3, 224
  s_cbranch_scc1 CLRD
  s_lshl_b32 s6, s59, 1
  s_add_u32 s6, s6, s58
  s_mul_i32 s6, s6, 14336
  s_lshl_b32 s7, s60, 8
  s_add_u32 s6, s6, s7
  s_add_u32 s6, s6, 1478656
  s_mov_b64 exec, 0xffff
  buffer_store_dwordx4 v[44:47], v163, s[36:39], s6 offen sc1
  s_mov_b64 exec, -1
CLRD:
  s_branch NOP1LD
CLRW:
  s_waitcnt vmcnt(0)
  s_branch P1MID
LOADER:
  v_lshl_add_u32 v3, v2, 15, v9
  s_lshl_b32 s6, s55, 21
  s_lshl_b32 s7, s54, 7
  s_add_u32 s6, s6, s7
  s_mov_b32 s50, 0
  s_mov_b32 s40, s14
  s_mov_b32 s41, s15
  s_mov_b32 s42, 8388608
  s_mov_b32 s43, 0x20000
  s_mov_b32 m0, 0
  s_add_u32 s51, s50, 8
L50:
  buffer_load_dwordx4 v3, s[40:43], s6 offen nt lds
  s_add_u32 m0, m0, 0x400
  s_add_u32 s6, s6, 8192
  buffer_load_dwordx4 v3, s[40:43], s6 offen nt lds
  s_add_u32 m0, m0, 0x400
  s_add_u32 s6, s6, 8192
  buffer_load_dwordx4 v3, s[40:43], s6 offen nt lds
  s_add_u32 m0, m0, 0x400
  s_add_u32 s6, s6, 8192
  buffer_load_dwordx4 v3, s[40:43], s6 offen nt lds
  s_add_u32 m0, m0, 0x400
  s_add_u32 s6, s6, 237568
  s_add_u32 s50, s50, 1
  s_cmp_lt_u32 s50, s51
  s_cbranch_scc1 L50
  v_lshrrev_b32 v4, 4, v1
  v_and_b32 v5, 15, v1
  v_xor_b32 v5, v5, v4
  v_lshlrev_b32 v5, 4, v5
  v_lshl_add_u32 v4, v4, 8, v5
  v_xor_b32 v5, 64, v4
  v_xor_b32 v6, 128, v4
  v_xor_b32 v7, 192, v4
  s_lshl_b32 s61, s55, 24
  s_lshl_b32 s7, s54, 14
  s_add_u32 s61, s61, s7
  s_add_u32 s61, s61, 15728640
  s_mov_b32 s6, s61
  s_barrier
  v_mul_u32_u24 v3, 49152, v2
  v_add_u32 v3, v3, v9
  s_mul_i32 s6, s55, 3145728
  s_lshl_b32 s7, s54, 7
  s_add_u32 s6, s6, s7
  s_add_u32 s6, s6, 4096
  s_mov_b32 s40, s28
  s_mov_b32 s41, s29
  s_mov_b32 s42, 12582912
  s_mov_b32 s43, 0x20000
  s_mov_b32 m0, 81920
  s_add_u32 s51, s50, 8
L51:
  buffer_load_dwordx4 v3, s[40:43], s6 offen nt lds
  s_add_u32 m0, m0, 0x400
  s_add_u32 s6, s6, 12288
  buffer_load_dwordx4 v3, s[40:43], s6 offen nt lds
  s_add_u32 m0, m0, 0x400
  s_add_u32 s6, s6, 12288
  buffer_load_dwordx4 v3, s[40:43], s6 offen nt lds
  s_add_u32 m0, m0, 0x400
  s_add_u32 s6, s6, 12288
  buffer_load_dwordx4 v3, s[40:43], s6 offen nt lds
  s_add_u32 m0, m0, 0x400
  s_add_u32 s6, s6, 356352
  s_add_u32 s50, s50, 1
  s_sub_u32 s7, s50, 2
  v_mov_b32 v14, s7
  s_waitcnt vmcnt(8)
  ds_max_i32 v15, v14
  s_cmp_lt_u32 s50, s51
  s_cbranch_scc1 L51
  ds_read_b32 v14, v15 offset:52
  s_waitcnt lgkmcnt(0)
  v_cmp_gt_i32 vcc, 4, v14
  s_cbranch_vccz L52
  s_sub_u32 s7, s50, 1
  v_mov_b32 v14, s7
  s_waitcnt vmcnt(4)
  ds_max_i32 v15, v14
  s_sub_u32 s7, s50, 0
  v_mov_b32 v14, s7
  s_waitcnt vmcnt(0)
  ds_max_i32 v15, v14
L53:
  s_sub_u32 s49, s49, 1
  s_cbranch_scc1 TIMEOUT
  s_sleep 1
  ds_read_b32 v14, v15 offset:52
  s_waitcnt lgkmcnt(0)
  v_cmp_gt_i32 vcc, 4, v14
  s_cbranch_vccnz L53
L52:
  s_mov_b32 s6, s61
  s_mov_b32 s40, s10
  s_mov_b32 s41, s11
  s_mov_b32 s42, 67108864
  s_mov_b32 s43, 0x20000
  s_mov_b32 m0, 32768
  s_add_u32 s51, s50, 4
L54:
  buffer_load_dwordx4 v4, s[40:43], s6 offen nt lds
  s_add_u32 m0, m0, 0x400
  s_add_u32 s6, s6, 1024
  buffer_load_dwordx4 v5, s[40:43], s6 offen nt lds
  s_add_u32 m0, m0, 0x400
  s_add_u32 s6, s6, 1024
  buffer_load_dwordx4 v6, s[40:43], s6 offen nt lds
  s_add_u32 m0, m0, 0x400
  s_add_u32 s6, s6, 1024
  buffer_load_dwordx4 v7, s[40:43], s6 offen nt lds
  s_add_u32 m0, m0, 0x400
  s_add_u32 s6, s6, 1024
  s_add_u32 s50, s50, 1
  s_sub_u32 s7, s50, 8
  v_mov_b32 v14, s7
  s_waitcnt vmcnt(32)
  ds_max_i32 v15, v14
  s_cmp_lt_u32 s50, s51
  s_cbranch_scc1 L54
  s_mov_b32 s6, s61
  s_mov_b32 s40, s12
  s_mov_b32 s41, s13
  s_mov_b32 s42, 67108864
  s_mov_b32 s43, 0x20000
  s_mov_b32 m0, 65536
  s_add_u32 s51, s50, 4
L55:
  buffer_load_dwordx4 v4, s[40:43], s6 offen nt lds
  s_add_u32 m0, m0, 0x400
  s_add_u32 s6, s6, 1024
  buffer_load_dwordx4 v5, s[40:43], s6 offen nt lds
  s_add_u32 m0, m0, 0x400
  s_add_u32 s6, s6, 1024
  buffer_load_dwordx4 v6, s[40:43], s6 offen nt lds
  s_add_u32 m0, m0, 0x400
  s_add_u32 s6, s6, 1024
  buffer_load_dwordx4 v7, s[40:43], s6 offen nt lds
  s_add_u32 m0, m0, 0x400
  s_add_u32 s6, s6, 1024
  s_add_u32 s50, s50, 1
  s_sub_u32 s7, s50, 8
  v_mov_b32 v14, s7
  s_waitcnt vmcnt(32)
  ds_max_i32 v15, v14
  s_cmp_lt_u32 s50, s51
  s_cbranch_scc1 L55
  v_lshl_add_u32 v8, v2, 13, v9
  s_lshl_b32 s6, s57, 19
  s_lshl_b32 s7, s56, 7
  s_add_u32 s6, s6, s7
  ds_read_b32 v14, v15 offset:56
  s_waitcnt lgkmcnt(0)
  v_cmp_gt_i32 vcc, 4, v14
  s_cbranch_vccz L56
  s_sub_u32 s7, s50, 7
  v_mov_b32 v14, s7
  s_waitcnt vmcnt(28)
  ds_max_i32 v15, v14
  s_sub_u32 s7, s50, 6
  v_mov_b32 v14, s7
  s_waitcnt vmcnt(24)
  ds_max_i32 v15, v14
  s_sub_u32 s7, s50, 5
  v_mov_b32 v14, s7
  s_waitcnt vmcnt(20)
  ds_max_i32 v15, v14
  s_sub_u32 s7, s50, 4
  v_mov_b32 v14, s7
  s_waitcnt vmcnt(16)
  ds_max_i32 v15, v14
  s_sub_u32 s7, s50, 3
  v_mov_b32 v14, s7
  s_waitcnt vmcnt(12)
  ds_max_i32 v15, v14
  s_sub_u32 s7, s50, 2
  v_mov_b32 v14, s7
  s_waitcnt vmcnt(8)
  ds_max_i32 v15, v14
  s_sub_u32 s7, s50, 1
  v_mov_b32 v14, s7
  s_waitcnt vmcnt(4)
  ds_max_i32 v15, v14
  s_sub_u32 s7, s50, 0
  v_mov_b32 v14, s7
  s_waitcnt vmcnt(0)
  ds_max_i32 v15, v14
L57:
  s_sub_u32 s49, s49, 1
  s_cbranch_scc1 TIMEOUT
  s_sleep 1
  ds_read_b32 v14, v15 offset:56
  s_waitcnt lgkmcnt(0)
  v_cmp_gt_i32 vcc, 4, v14
  s_cbranch_vccnz L57
L56:
  s_mov_b32 s40, s16
  s_mov_b32 s41, s17
  s_mov_b32 s42, 8388608
  s_mov_b32 s43, 0x20000
  s_mov_b32 m0, 114688
  s_add_u32 s51, s50, 8
L58:
  buffer_load_dwordx4 v8, s[40:43], s6 offen nt lds
  s_add_u32 m0, m0, 0x400
  s_add_u32 s6, s6, 2048
  buffer_load_dwordx4 v8, s[40:43], s6 offen nt lds
  s_add_u32 m0, m0, 0x400
  s_add_u32 s6, s6, 2048
  buffer_load_dwordx4 v8, s[40:43], s6 offen nt lds
  s_add_u32 m0, m0, 0x400
  s_add_u32 s6, s6, 2048
  buffer_load_dwordx4 v8, s[40:43], s6 offen nt lds
  s_add_u32 m0, m0, 0x400
  s_add_u32 s6, s6, 59392
  s_add_u32 s50, s50, 1
  s_sub_u32 s7, s50, 4
  v_mov_b32 v14, s7
  s_waitcnt vmcnt(16)
  ds_max_i32 v15, v14
  s_cmp_lt_u32 s50, s51
  s_cbranch_scc1 L58
  s_cmp_ge_u32 s3, 224
  s_cbranch_scc1 NOP5
  ds_read_b32 v14, v15 offset:4
  s_waitcnt lgkmcnt(0)
  v_cmp_gt_i32 vcc, 12, v14
  s_cbranch_vccz L59
  s_sub_u32 s7, s50, 3
  v_mov_b32 v14, s7
  s_waitcnt vmcnt(12)
  ds_max_i32 v15, v14
  s_sub_u32 s7, s50, 2
  v_mov_b32 v14, s7
  s_waitcnt vmcnt(8)
  ds_max_i32 v15, v14
  s_sub_u32 s7, s50, 1
  v_mov_b32 v14, s7
  s_waitcnt vmcnt(4)
  ds_max_i32 v15, v14
  s_sub_u32 s7, s50, 0
  v_mov_b32 v14, s7
  s_waitcnt vmcnt(0)
  ds_max_i32 v15, v14
L60:
  s_sub_u32 s49, s49, 1
  s_cbranch_scc1 TIMEOUT
  s_sleep 1
  ds_read_b32 v14, v15 offset:4
  s_waitcnt lgkmcnt(0)
  v_cmp_gt_i32 vcc, 12, v14
  s_cbranch_vccnz L60
L59:
  ds_read_b32 v14, v15 offset:60
  s_waitcnt lgkmcnt(0)
  v_cmp_gt_i32 vcc, 4, v14
  s_cbranch_vccz L61
  s_sub_u32 s7, s50, 3
  v_mov_b32 v14, s7
  s_waitcnt vmcnt(12)
  ds_max_i32 v15, v14
  s_sub_u32 s7, s50, 2
  v_mov_b32 v14, s7
  s_waitcnt vmcnt(8)
  ds_max_i32 v15, v14
  s_sub_u32 s7, s50, 1
  v_mov_b32 v14, s7
  s_waitcnt vmcnt(4)
  ds_max_i32 v15, v14
  s_sub_u32 s7, s50, 0
  v_mov_b32 v14, s7
  s_waitcnt vmcnt(0)
  ds_max_i32 v15, v14
L62:
  s_sub_u32 s49, s49, 1
  s_cbranch_scc1 TIMEOUT
  s_sleep 1
  ds_read_b32 v14, v15 offset:60
  s_waitcnt lgkmcnt(0)
  v_cmp_gt_i32 vcc, 4, v14
  s_cbranch_vccnz L62
L61:
  v_mul_u32_u24 v3, 28672, v2
  v_add_u32 v3, v3, v9
  s_mul_i32 s6, s58, 3670016
  s_lshl_b32 s7, s60, 7
  s_add_u32 s6, s6, s7
  s_cmp_eq_u32 s59, 1
  s_cselect_b32 s62, s22, s20
  s_cselect_b32 s63, s23, s21
  s_mov_b32 s40, s62
  s_mov_b32 s41, s63
  s_mov_b32 s42, 7340032
  s_mov_b32 s43, 0x20000
  s_mov_b32 m0, 0
  s_add_u32 s51, s50, 16
L63:
  buffer_load_dwordx4 v3, s[40:43], s6 offen nt lds
  s_add_u32 m0, m0, 0x400
  s_add_u32 s6, s6, 7168
  buffer_load_dwordx4 v3, s[40:43], s6 offen nt lds
  s_add_u32 m0, m0, 0x400
  s_add_u32 s6, s6, 7168
  buffer_load_dwordx4 v3, s[40:43], s6 offen nt lds
  s_add_u32 m0, m0, 0x400
  s_add_u32 s6, s6, 7168
  buffer_load_dwordx4 v3, s[40:43], s6 offen nt lds
  s_add_u32 m0, m0, 0x400
  s_add_u32 s6, s6, 207872
  s_add_u32 s50, s50, 1
  s_sub_u32 s7, s50, 4
  v_mov_b32 v14, s7
  s_waitcnt vmcnt(16)
  ds_max_i32 v15, v14
  s_cmp_lt_u32 s50, s51
  s_cbranch_scc1 L63
  ds_read_b32 v14, v15 offset:88
  s_waitcnt lgkmcnt(0)
  v_cmp_gt_i32 vcc, 4, v14
  s_cbranch_vccz L64
  s_sub_u32 s7, s50, 3
  v_mov_b32 v14, s7
  s_waitcnt vmcnt(12)
  ds_max_i32 v15, v14
  s_sub_u32 s7, s50, 2
  v_mov_b32 v14, s7
  s_waitcnt vmcnt(8)
  ds_max_i32 v15, v14
  s_sub_u32 s7, s50, 1
  v_mov_b32 v14, s7
  s_waitcnt vmcnt(4)
  ds_max_i32 v15, v14
  s_sub_u32 s7, s50, 0
  v_mov_b32 v14, s7
  s_waitcnt vmcnt(0)
  ds_max_i32 v15, v14
L65:
  s_sub_u32 s49, s49, 1
  s_cbranch_scc1 TIMEOUT
  s_sleep 1
  ds_read_b32 v14, v15 offset:88
  s_waitcnt lgkmcnt(0)
  v_cmp_gt_i32 vcc, 4, v14
  s_cbranch_vccnz L65
L64:
  s_branch YESP5
NOP5:
  s_sub_u32 s7, s50, 3
  v_mov_b32 v14, s7
  s_waitcnt vmcnt(12)
  ds_max_i32 v15, v14
  s_sub_u32 s7, s50, 2
  v_mov_b32 v14, s7
  s_waitcnt vmcnt(8)
  ds_max_i32 v15, v14
  s_sub_u32 s7, s50, 1
  v_mov_b32 v14, s7
  s_waitcnt vmcnt(4)
  ds_max_i32 v15, v14
  s_sub_u32 s7, s50, 0
  v_mov_b32 v14, s7
  s_waitcnt vmcnt(0)
  ds_max_i32 v15, v14
  s_mov_b32 s50, 48
YESP5:
  ds_read_b32 v14, v15 offset:8
  s_waitcnt lgkmcnt(0)
  v_cmp_gt_i32 vcc, 8, v14
  s_cbranch_vccz L66
  s_sub_u32 s7, s50, 3
  v_mov_b32 v14, s7
  s_waitcnt vmcnt(12)
  ds_max_i32 v15, v14
  s_sub_u32 s7, s50, 2
  v_mov_b32 v14, s7
  s_waitcnt vmcnt(8)
  ds_max_i32 v15, v14
  s_sub_u32 s7, s50, 1
  v_mov_b32 v14, s7
  s_waitcnt vmcnt(4)
  ds_max_i32 v15, v14
  s_sub_u32 s7, s50, 0
  v_mov_b32 v14, s7
  s_waitcnt vmcnt(0)
  ds_max_i32 v15, v14
L67:
  s_sub_u32 s49, s49, 1
  s_cbranch_scc1 TIMEOUT
  s_sleep 1
  ds_read_b32 v14, v15 offset:8
  s_waitcnt lgkmcnt(0)
  v_cmp_gt_i32 vcc, 8, v14
  s_cbranch_vccnz L67
L66:
  s_mul_i32 s6, s57, 458752
  s_lshl_b32 s7, s56, 7
  s_add_u32 s6, s6, s7
  s_mov_b32 s40, s24
  s_mov_b32 s41, s25
  s_mov_b32 s42, 7340032
  s_mov_b32 s43, 0x20000
  s_mov_b32 m0, 81920
  s_add_u32 s51, s50, 7
L68:
  buffer_load_dwordx4 v8, s[40:43], s6 offen nt lds
  s_add_u32 m0, m0, 0x400
  s_add_u32 s6, s6, 2048
  buffer_load_dwordx4 v8, s[40:43], s6 offen nt lds
  s_add_u32 m0, m0, 0x400
  s_add_u32 s6, s6, 2048
  buffer_load_dwordx4 v8, s[40:43], s6 offen nt lds
  s_add_u32 m0, m0, 0x400
  s_add_u32 s6, s6, 2048
  buffer_load_dwordx4 v8, s[40:43], s6 offen nt lds
  s_add_u32 m0, m0, 0x400
  s_add_u32 s6, s6, 59392
  s_add_u32 s50, s50, 1
  s_sub_u32 s7, s50, 5
  v_mov_b32 v14, s7
  s_waitcnt vmcnt(20)
  ds_max_i32 v15, v14
  s_cmp_lt_u32 s50, s51
  s_cbranch_scc1 L68
  s_sub_u32 s7, s50, 4
  v_mov_b32 v14, s7
  s_waitcnt vmcnt(16)
  ds_max_i32 v15, v14
  s_sub_u32 s7, s50, 3
  v_mov_b32 v14, s7
  s_waitcnt vmcnt(12)
  ds_max_i32 v15, v14
  s_sub_u32 s7, s50, 2
  v_mov_b32 v14, s7
  s_waitcnt vmcnt(8)
  ds_max_i32 v15, v14
  s_sub_u32 s7, s50, 1
  v_mov_b32 v14, s7
  s_waitcnt vmcnt(4)
  ds_max_i32 v15, v14
  s_sub_u32 s7, s50, 0
  v_mov_b32 v14, s7
  s_waitcnt vmcnt(0)
  ds_max_i32 v15, v14
  s_waitcnt lgkmcnt(0)
  s_endpgm
.section .rodata,"a"
.p2align 6
.amdhsa_kernel adaLN_cond__sliding_block_cached__geglu_ffn__decode_kernel
  .amdhsa_next_free_vgpr 168
  .amdhsa_next_free_sgpr 96
  .amdhsa_accum_offset 168
  .amdhsa_group_segment_fixed_size 0
  .amdhsa_kernarg_size 112
  .amdhsa_user_sgpr_count 2
  .amdhsa_user_sgpr_kernarg_segment_ptr 1
  .amdhsa_system_sgpr_workgroup_id_x 1
.end_amdhsa_kernel
```
